```python
import torch

def _softmax(x, axis=-1):
    return torch.softmax(x, dim=axis)
def _gelu(x):
    return torch.nn.functional.gelu(x, approximate="tanh")
def _silu(x):
    return torch.nn.functional.silu(x)
def _sigmoid(x):
    return torch.sigmoid(x)
def _layernorm(x, axis=-1, eps=1e-5):
    m = x.mean(dim=axis, keepdim=True)
    v = x.var(dim=axis, keepdim=True, unbiased=False)
    return (x - m) / torch.sqrt(v + eps)
def _scatter_add(tgt, idx, src, axis=0):
    return tgt.clone().index_add_(axis, idx, src)
def _segment_sum(src, seg, n):
    out = torch.zeros((n,) + src.shape[1:], dtype=src.dtype)
    return out.index_add_(0, seg, src)
def _pad(x, pw):
    flat = tuple(v for pair in reversed(pw) for v in pair)
    return torch.nn.functional.pad(x, flat)

kernel_name = 'parallel_sum__sliding_block__mixer_token_mlp__prompt'

def setup_inputs():

    _w = (lambda a: (lambda t: t.to(torch.bfloat16) if t.is_floating_point() else t)(torch.as_tensor(a)))
    def _A_setup():
        B, S, D = 1, 2048, 640
        return {
            "x": _w((lambda *s: torch.randn(*s, dtype=torch.bfloat16) * 0.05)(B, S, D)),
            "wqkv": _w((lambda *s: torch.randn(*s, dtype=torch.bfloat16) * 0.05)(D, 3 * D)),
            "wo": _w((lambda *s: torch.randn(*s, dtype=torch.bfloat16) * 0.05)(D, D)),
        }
    _A_in = _A_setup()

    def _B_setup():
        B, S, D, F = 1, 2048, 640, 1536
        return {
            "x": _w((lambda *s: torch.randn(*s, dtype=torch.bfloat16) * 0.05)(B, S, D)),
            "w1": _w((lambda *s: torch.randn(*s, dtype=torch.bfloat16) * 0.8)(S, F) * (S ** -0.5)),
            "b1": _w((lambda *s: torch.randn(*s, dtype=torch.bfloat16) * 0.8)(F) * 0.02),
            "w2": _w((lambda *s: torch.randn(*s, dtype=torch.bfloat16) * 0.8)(F, S) * (F ** -0.5)),
            "b2": _w((lambda *s: torch.randn(*s, dtype=torch.bfloat16) * 0.8)(S) * 0.02),
        }
    _B_in = _B_setup()

    return {
        "A_x": _A_in["x"],
        "A_wqkv": _A_in["wqkv"],
        "A_wo": _A_in["wo"],
        "B_x": _B_in["x"],
        "B_w1": _B_in["w1"],
        "B_b1": _B_in["b1"],
        "B_w2": _B_in["w2"],
        "B_b2": _B_in["b2"],
    }

def reference(A_x, A_wqkv, A_wo, B_x, B_w1, B_b1, B_w2, B_b2):
    def _A_ref(x, wqkv, wo):
        B, S, D = x.shape
        H = 32; Dh = D // H; W = 256
        qkv = (lambda x, *d: x.permute(*d))((x @ wqkv).reshape(B, S, 3, H, Dh), 2, 0, 3, 1, 4)
        q, k, v = qkv[0], qkv[1], qkv[2]
        scores = torch.einsum("bhqd,bhkd->bhqk", q, k) * (Dh ** -0.5)
        idx = torch.arange(S)
        mask = (idx[:, None] - idx[None, :] >= 0) & (idx[:, None] - idx[None, :] < W)
        scores = torch.where(mask[None, None], scores, -1e9)
        p = _softmax(scores, axis=-1)
        o = torch.einsum("bhqk,bhkd->bhqd", p, v)
        return (lambda x, *d: x.permute(*d))(o, 0, 2, 1, 3).reshape(B, S, D) @ wo

    def _B_ref(x, w1, b1, w2, b2):
        B, S, D = x.shape
        h = _layernorm(x, axis=-1)
        u = torch.einsum("bsd,sf->bdf", h, w1) + b1
        u = _gelu(u)
        y = torch.einsum("bdf,fs->bds", u, w2) + b2
        return (lambda x, *d: x.permute(*d))(y, 0, 2, 1)

    x = A_x
    xn = _layernorm(x, axis=-1)
    return x + _A_ref(xn, A_wqkv, A_wo) + _B_ref(xn, B_w1, B_b1, B_w2, B_b2)
```

```asm
; @launch grid=(256,1,1) block=(512,1,1) lds=163840
.amdgcn_target "amdgcn-amd-amdhsa--gfx950"
.text
.globl parallel_sum__sliding_block__mixer_token_mlp__prompt_kernel
.p2align 8
.type parallel_sum__sliding_block__mixer_token_mlp__prompt_kernel,@function
parallel_sum__sliding_block__mixer_token_mlp__prompt_kernel:
  s_mov_b32 s101, 0
  s_load_dwordx4 s[4:7], s[0:1], 0
  s_load_dwordx2 s[20:21], s[0:1], 80
  s_load_dwordx2 s[42:43], s[0:1], 72
  s_load_dwordx4 s[52:55], s[0:1], 32
  s_load_dwordx2 s[62:63], s[0:1], 56
  s_load_dwordx2 s[90:91], s[0:1], 64
  s_cmp_ge_u32 s2, 256
  s_cbranch_scc1 Lm_exit
  s_lshr_b32 s33, s2, 3
  s_and_b32 s34, s2, 7
  s_lshr_b32 s25, s34, 1
  s_lshl_b32 s25, s25, 2
  v_and_b32 v1, 63, v0
  v_lshrrev_b32 v24, 6, v0
  s_and_b32 s35, s33, 3
  v_readfirstlane_b32 s22, v24
  s_add_u32 s25, s25, s35
  s_lshr_b32 s26, s33, 2
  s_and_b32 s34, s34, 1
  s_cmp_eq_u32 s34, 0
  s_cbranch_scc1 La_gemm
  s_cmp_eq_u32 s26, 0
  s_cbranch_scc1 La_ln
  s_add_u32 s26, s26, 7
La_gemm:
  s_lshl_b32 s3, s25, 4
  s_add_u32 s3, s3, s26
  s_cmp_ge_u32 s22, 4
  s_cbranch_scc1 La_loader
  s_lshr_b32 s23, s22, 1
  s_and_b32 s24, s22, 1
  v_bfe_u32 v27, v1, 2, 2
  v_lshrrev_b32 v28, 5, v1
  v_lshl_add_u32 v29, v28, 3, v27
  v_lshlrev_b32 v29, 8, v29
  v_and_b32 v30, 3, v1
  v_lshl_add_u32 v29, v30, 3, v29
  v_bfe_u32 v30, v1, 4, 1
  v_lshl_add_u32 v29, v30, 5, v29
  s_lshl_b32 s33, s24, 1
  s_add_u32 s33, s33, s23
  v_xor_b32 v30, s33, v27
  v_lshl_add_u32 v2, v30, 6, v29
  v_xor_b32 v3, 64, v2
  v_and_b32 v29, 31, v1
  s_lshl_b32 s33, s23, 6
  v_add_u32 v29, s33, v29
  v_lshlrev_b32 v29, 7, v29
  v_add_u32 v29, 16384, v29
  v_bfe_u32 v30, v1, 1, 3
  v_xor_b32 v30, v30, v28
  v_xor_b32 v31, 0, v30
  v_lshl_add_u32 v4, v31, 4, v29
  v_xor_b32 v31, 2, v30
  v_lshl_add_u32 v5, v31, 4, v29
  v_xor_b32 v31, 4, v30
  v_lshl_add_u32 v6, v31, 4, v29
  v_xor_b32 v31, 6, v30
  v_lshl_add_u32 v7, v31, 4, v29
  v_mov_b32 v8, v2
  v_mov_b32 v9, v3
  v_mov_b32 v10, v4
  v_mov_b32 v11, v5
  v_mov_b32 v12, v6
  v_mov_b32 v13, v7
  v_and_b32 v29, 15, v1
  v_bfe_u32 v30, v1, 4, 1
  v_cmp_eq_u32 vcc, v29, v30
  v_mov_b32 v31, 0x3f803f80
  s_nop 0
  v_cndmask_b32 v16, 0, v31, vcc
  v_mov_b32 v17, v16
  v_mov_b32 v18, v16
  v_mov_b32 v19, v16
  v_mov_b32 v20, 0
  v_mov_b32 v21, 0
  v_mov_b32 v22, 0
  v_mov_b32 v23, 0
  v_mov_b32 v64, 0
  v_mov_b32 v65, 0
  v_mov_b32 v66, 0
  v_mov_b32 v67, 0
  v_mov_b32 v68, 0
  v_mov_b32 v69, 0
  v_mov_b32 v70, 0
  v_mov_b32 v71, 0
  v_mov_b32 v72, 0
  v_mov_b32 v73, 0
  v_mov_b32 v74, 0
  v_mov_b32 v75, 0
  v_mov_b32 v76, 0
  v_mov_b32 v77, 0
  v_mov_b32 v78, 0
  v_mov_b32 v79, 0
  v_mov_b32 v80, 0
  v_mov_b32 v81, 0
  v_mov_b32 v82, 0
  v_mov_b32 v83, 0
  v_mov_b32 v84, 0
  v_mov_b32 v85, 0
  v_mov_b32 v86, 0
  v_mov_b32 v87, 0
  v_mov_b32 v88, 0
  v_mov_b32 v89, 0
  v_mov_b32 v90, 0
  v_mov_b32 v91, 0
  v_mov_b32 v92, 0
  v_mov_b32 v93, 0
  v_mov_b32 v94, 0
  v_mov_b32 v95, 0
  v_mov_b32 v96, 0
  v_mov_b32 v97, 0
  v_mov_b32 v98, 0
  v_mov_b32 v99, 0
  v_mov_b32 v100, 0
  v_mov_b32 v101, 0
  v_mov_b32 v102, 0
  v_mov_b32 v103, 0
  v_mov_b32 v104, 0
  v_mov_b32 v105, 0
  v_mov_b32 v106, 0
  v_mov_b32 v107, 0
  v_mov_b32 v108, 0
  v_mov_b32 v109, 0
  v_mov_b32 v110, 0
  v_mov_b32 v111, 0
  v_mov_b32 v112, 0
  v_mov_b32 v113, 0
  v_mov_b32 v114, 0
  v_mov_b32 v115, 0
  v_mov_b32 v116, 0
  v_mov_b32 v117, 0
  v_mov_b32 v118, 0
  v_mov_b32 v119, 0
  v_mov_b32 v120, 0
  v_mov_b32 v121, 0
  v_mov_b32 v122, 0
  v_mov_b32 v123, 0
  v_mov_b32 v124, 0
  v_mov_b32 v125, 0
  v_mov_b32 v126, 0
  v_mov_b32 v127, 0
  s_cmp_ge_u32 s26, 10
  s_cbranch_scc1 La_noha
  s_cmp_ge_u32 s26, 5
  s_cselect_b32 s33, 5, 0
  s_sub_u32 s33, s26, s33
  s_lshl_b32 s33, s33, 5
  v_lshrrev_b32 v24, 5, v1
  v_and_b32 v25, 31, v1
  s_lshl_b32 s34, s23, 6
  v_add_u32 v25, s34, v25
  v_add_u32 v26, 32, v25
  s_xor_b32 s34, s23, 0
  s_lshl_b32 s34, s34, 3
  s_lshl_b32 s35, s24, 4
  s_add_u32 s34, s34, s35
  s_add_u32 s35, s34, 0
  v_add_u32 v27, s35, v24
  v_add_u32 v28, s33, v27
  v_mul_u32_u24 v28, 205, v28
  v_lshrrev_b32 v28, 10, v28
  v_mul_u32_u24 v28, 5, v28
  v_subrev_u32 v28, s33, v28
  v_add_u32 v29, 5, v28
  v_min_i32 v29, 32, v29
  v_max_i32 v28, 0, v28
  v_sub_u32 v29, v29, v28
  v_lshlrev_b32 v29, 3, v29
  v_sub_u32 v27, v27, v28
  v_lshlrev_b32 v27, 3, v27
  v_lshl_add_u32 v27, v28, 10, v27
  v_add_u32 v27, 98304, v27
  v_mad_u32_u24 v200, v25, v29, v27
  v_mad_u32_u24 v208, v26, v29, v27
  s_add_u32 s35, s34, 2
  v_add_u32 v27, s35, v24
  v_add_u32 v28, s33, v27
  v_mul_u32_u24 v28, 205, v28
  v_lshrrev_b32 v28, 10, v28
  v_mul_u32_u24 v28, 5, v28
  v_subrev_u32 v28, s33, v28
  v_add_u32 v29, 5, v28
  v_min_i32 v29, 32, v29
  v_max_i32 v28, 0, v28
  v_sub_u32 v29, v29, v28
  v_lshlrev_b32 v29, 3, v29
  v_sub_u32 v27, v27, v28
  v_lshlrev_b32 v27, 3, v27
  v_lshl_add_u32 v27, v28, 10, v27
  v_add_u32 v27, 98304, v27
  v_mad_u32_u24 v201, v25, v29, v27
  v_mad_u32_u24 v209, v26, v29, v27
  s_add_u32 s35, s34, 4
  v_add_u32 v27, s35, v24
  v_add_u32 v28, s33, v27
  v_mul_u32_u24 v28, 205, v28
  v_lshrrev_b32 v28, 10, v28
  v_mul_u32_u24 v28, 5, v28
  v_subrev_u32 v28, s33, v28
  v_add_u32 v29, 5, v28
  v_min_i32 v29, 32, v29
  v_max_i32 v28, 0, v28
  v_sub_u32 v29, v29, v28
  v_lshlrev_b32 v29, 3, v29
  v_sub_u32 v27, v27, v28
  v_lshlrev_b32 v27, 3, v27
  v_lshl_add_u32 v27, v28, 10, v27
  v_add_u32 v27, 98304, v27
  v_mad_u32_u24 v202, v25, v29, v27
  v_mad_u32_u24 v210, v26, v29, v27
  s_add_u32 s35, s34, 6
  v_add_u32 v27, s35, v24
  v_add_u32 v28, s33, v27
  v_mul_u32_u24 v28, 205, v28
  v_lshrrev_b32 v28, 10, v28
  v_mul_u32_u24 v28, 5, v28
  v_subrev_u32 v28, s33, v28
  v_add_u32 v29, 5, v28
  v_min_i32 v29, 32, v29
  v_max_i32 v28, 0, v28
  v_sub_u32 v29, v29, v28
  v_lshlrev_b32 v29, 3, v29
  v_sub_u32 v27, v27, v28
  v_lshlrev_b32 v27, 3, v27
  v_lshl_add_u32 v27, v28, 10, v27
  v_add_u32 v27, 98304, v27
  v_mad_u32_u24 v203, v25, v29, v27
  v_mad_u32_u24 v211, v26, v29, v27
  s_xor_b32 s34, s23, 1
  s_lshl_b32 s34, s34, 3
  s_lshl_b32 s35, s24, 4
  s_add_u32 s34, s34, s35
  s_add_u32 s35, s34, 0
  v_add_u32 v27, s35, v24
  v_add_u32 v28, s33, v27
  v_mul_u32_u24 v28, 205, v28
  v_lshrrev_b32 v28, 10, v28
  v_mul_u32_u24 v28, 5, v28
  v_subrev_u32 v28, s33, v28
  v_add_u32 v29, 5, v28
  v_min_i32 v29, 32, v29
  v_max_i32 v28, 0, v28
  v_sub_u32 v29, v29, v28
  v_lshlrev_b32 v29, 3, v29
  v_sub_u32 v27, v27, v28
  v_lshlrev_b32 v27, 3, v27
  v_lshl_add_u32 v27, v28, 10, v27
  v_add_u32 v27, 98304, v27
  v_mad_u32_u24 v204, v25, v29, v27
  v_mad_u32_u24 v212, v26, v29, v27
  s_add_u32 s35, s34, 2
  v_add_u32 v27, s35, v24
  v_add_u32 v28, s33, v27
  v_mul_u32_u24 v28, 205, v28
  v_lshrrev_b32 v28, 10, v28
  v_mul_u32_u24 v28, 5, v28
  v_subrev_u32 v28, s33, v28
  v_add_u32 v29, 5, v28
  v_min_i32 v29, 32, v29
  v_max_i32 v28, 0, v28
  v_sub_u32 v29, v29, v28
  v_lshlrev_b32 v29, 3, v29
  v_sub_u32 v27, v27, v28
  v_lshlrev_b32 v27, 3, v27
  v_lshl_add_u32 v27, v28, 10, v27
  v_add_u32 v27, 98304, v27
  v_mad_u32_u24 v205, v25, v29, v27
  v_mad_u32_u24 v213, v26, v29, v27
  s_add_u32 s35, s34, 4
  v_add_u32 v27, s35, v24
  v_add_u32 v28, s33, v27
  v_mul_u32_u24 v28, 205, v28
  v_lshrrev_b32 v28, 10, v28
  v_mul_u32_u24 v28, 5, v28
  v_subrev_u32 v28, s33, v28
  v_add_u32 v29, 5, v28
  v_min_i32 v29, 32, v29
  v_max_i32 v28, 0, v28
  v_sub_u32 v29, v29, v28
  v_lshlrev_b32 v29, 3, v29
  v_sub_u32 v27, v27, v28
  v_lshlrev_b32 v27, 3, v27
  v_lshl_add_u32 v27, v28, 10, v27
  v_add_u32 v27, 98304, v27
  v_mad_u32_u24 v206, v25, v29, v27
  v_mad_u32_u24 v214, v26, v29, v27
  s_add_u32 s35, s34, 6
  v_add_u32 v27, s35, v24
  v_add_u32 v28, s33, v27
  v_mul_u32_u24 v28, 205, v28
  v_lshrrev_b32 v28, 10, v28
  v_mul_u32_u24 v28, 5, v28
  v_subrev_u32 v28, s33, v28
  v_add_u32 v29, 5, v28
  v_min_i32 v29, 32, v29
  v_max_i32 v28, 0, v28
  v_sub_u32 v29, v29, v28
  v_lshlrev_b32 v29, 3, v29
  v_sub_u32 v27, v27, v28
  v_lshlrev_b32 v27, 3, v27
  v_lshl_add_u32 v27, v28, 10, v27
  v_add_u32 v27, 98304, v27
  v_mad_u32_u24 v207, v25, v29, v27
  v_mad_u32_u24 v215, v26, v29, v27
La_noha:
  s_mov_b32 s27, 0
  s_mov_b32 s31, 32768
  s_add_u32 s33, s26, s25
  s_and_b32 s33, s33, 7
  s_add_u32 s60, s33, 1
  s_cmp_eq_u32 s22, 0
  s_cselect_b32 s60, s60, 99
  s_mul_i32 s33, s25, 15
  s_add_u32 s33, s33, s26
  s_lshl_b32 s33, s33, 8
  v_add_lshl_u32 v220, v1, s33, 7
  s_lshr_b32 s33, s2, 3
  s_and_b32 s34, s2, 1
  s_lshl_b32 s34, s34, 2
  s_sub_u32 s33, s33, s34
  s_mul_i32 s33, s33, 448
  s_and_b32 s34, s2, 7
  s_lshr_b32 s34, s34, 1
  s_mul_i32 s34, s34, 768
  s_movk_i32 s35, 10923
  v_add_u32 v24, s33, v1
  v_add_u32 v24, 0, v24
  v_mul_u32_u24 v25, s35, v24
  v_lshrrev_b32 v25, 16, v25
  v_mul_u32_u24 v26, 6, v25
  v_sub_u32 v26, v24, v26
  v_mul_u32_u24 v25, 3072, v25
  v_lshl_add_u32 v25, v26, 7, v25
  v_add_u32 v224, s34, v25
  v_add_u32 v24, s33, v1
  v_add_u32 v24, 64, v24
  v_mul_u32_u24 v25, s35, v24
  v_lshrrev_b32 v25, 16, v25
  v_mul_u32_u24 v26, 6, v25
  v_sub_u32 v26, v24, v26
  v_mul_u32_u24 v25, 3072, v25
  v_lshl_add_u32 v25, v26, 7, v25
  v_add_u32 v225, s34, v25
  v_add_u32 v24, s33, v1
  v_add_u32 v24, 128, v24
  v_mul_u32_u24 v25, s35, v24
  v_lshrrev_b32 v25, 16, v25
  v_mul_u32_u24 v26, 6, v25
  v_sub_u32 v26, v24, v26
  v_mul_u32_u24 v25, 3072, v25
  v_lshl_add_u32 v25, v26, 7, v25
  v_add_u32 v226, s34, v25
  v_add_u32 v24, s33, v1
  v_add_u32 v24, 192, v24
  v_mul_u32_u24 v25, s35, v24
  v_lshrrev_b32 v25, 16, v25
  v_mul_u32_u24 v26, 6, v25
  v_sub_u32 v26, v24, v26
  v_mul_u32_u24 v25, 3072, v25
  v_lshl_add_u32 v25, v26, 7, v25
  v_add_u32 v227, s34, v25
  v_add_u32 v24, s33, v1
  v_add_u32 v24, 256, v24
  v_mul_u32_u24 v25, s35, v24
  v_lshrrev_b32 v25, 16, v25
  v_mul_u32_u24 v26, 6, v25
  v_sub_u32 v26, v24, v26
  v_mul_u32_u24 v25, 3072, v25
  v_lshl_add_u32 v25, v26, 7, v25
  v_add_u32 v228, s34, v25
  v_add_u32 v24, s33, v1
  v_add_u32 v24, 320, v24
  v_mul_u32_u24 v25, s35, v24
  v_lshrrev_b32 v25, 16, v25
  v_mul_u32_u24 v26, 6, v25
  v_sub_u32 v26, v24, v26
  v_mul_u32_u24 v25, 3072, v25
  v_lshl_add_u32 v25, v26, 7, v25
  v_add_u32 v229, s34, v25
  v_add_u32 v24, s33, v1
  v_add_u32 v24, 384, v24
  v_mul_u32_u24 v25, s35, v24
  v_lshrrev_b32 v25, 16, v25
  v_mul_u32_u24 v26, 6, v25
  v_sub_u32 v26, v24, v26
  v_mul_u32_u24 v25, 3072, v25
  v_lshl_add_u32 v25, v26, 7, v25
  v_add_u32 v230, s34, v25
  s_waitcnt lgkmcnt(0)
  s_mov_b32 s48, s52
  s_and_b32 s49, s53, 0xffff
  s_mov_b32 s50, 6291456
  s_mov_b32 s51, 0x20000
  s_mov_b32 s56, s54
  s_and_b32 s57, s55, 0xffff
  s_mov_b32 s58, 3072
  s_mov_b32 s59, 0x20000
  s_mov_b32 s64, s62
  s_and_b32 s65, s63, 0xffff
  s_mov_b32 s66, 4096
  s_mov_b32 s67, 0x20000
  s_mov_b32 s92, s90
  s_and_b32 s93, s91, 0xffff
  s_mov_b32 s94, 2621440
  s_mov_b32 s95, 0x20000
  s_mov_b32 s44, s20
  s_and_b32 s45, s21, 0xffff
  s_mov_b32 s46, 16388096
  s_mov_b32 s47, 0x20000
  s_barrier
  s_cmp_ge_u32 s26, 10
  s_cbranch_scc1 La_v
  ds_read_b64_tr_b16 v[32:33], v8 offset:0
  ds_read_b64_tr_b16 v[34:35], v8 offset:1024
  ds_read_b128 v[40:43], v10 offset:0
  ds_read_b64_tr_b16 v[36:37], v9 offset:0
  ds_read_b64_tr_b16 v[38:39], v9 offset:1024
  ds_read_b128 v[44:47], v10 offset:4096
La_loop_q:
  s_waitcnt lgkmcnt(3)
  v_mfma_f32_32x32x16_bf16 v[64:79], v[32:35], v[40:43], v[64:79]
  s_cmp_eq_u32 s27, s60
  s_cbranch_scc0 La_nopf_q
  buffer_load_dword v221, v224, s[48:51], 0 offen
  buffer_load_dword v222, v225, s[48:51], 0 offen
  buffer_load_dword v221, v226, s[48:51], 0 offen
  buffer_load_dword v222, v227, s[48:51], 0 offen
  buffer_load_dword v221, v228, s[48:51], 0 offen
  buffer_load_dword v222, v229, s[48:51], 0 offen
  buffer_load_dword v221, v230, s[48:51], 0 offen
  v_lshlrev_b32 v220, 7, v1
  buffer_load_dword v221, v220, s[56:59], 0 offen
  buffer_load_dword v222, v220, s[64:67], 0 offen
  v_lshlrev_b32 v220, 20, v1
  buffer_load_dword v221, v220, s[44:47], 0 offen sc1
  buffer_load_dword v222, v220, s[92:95], 0 offen
La_nopf_q:
  ds_read_b64_tr_b16 v[48:49], v8 offset:4096
  ds_read_b64_tr_b16 v[50:51], v8 offset:5120
  s_waitcnt lgkmcnt(3)
  v_mfma_f32_32x32x16_bf16 v[80:95], v[36:39], v[40:43], v[80:95]
  ds_read_b128 v[56:59], v11 offset:0
  ds_read_b64_tr_b16 v[52:53], v9 offset:4096
  s_waitcnt lgkmcnt(4)
  v_mfma_f32_32x32x16_bf16 v[96:111], v[32:35], v[44:47], v[96:111]
  ds_read_b64_tr_b16 v[54:55], v9 offset:5120
  ds_read_b128 v[60:63], v11 offset:4096
  v_mfma_f32_32x32x16_bf16 v[112:127], v[36:39], v[44:47], v[112:127]
  v_mfma_f32_16x16x32_bf16 v[20:23], v[32:35], v[16:19], v[20:23]
  s_waitcnt lgkmcnt(3)
  v_mfma_f32_32x32x16_bf16 v[64:79], v[48:51], v[56:59], v[64:79]
  ds_read_b64_tr_b16 v[32:33], v8 offset:8192
  ds_read_b64_tr_b16 v[34:35], v8 offset:9216
  s_waitcnt lgkmcnt(3)
  v_mfma_f32_32x32x16_bf16 v[80:95], v[52:55], v[56:59], v[80:95]
  ds_read_b128 v[40:43], v12 offset:0
  ds_read_b64_tr_b16 v[36:37], v9 offset:8192
  s_waitcnt lgkmcnt(4)
  v_mfma_f32_32x32x16_bf16 v[96:111], v[48:51], v[60:63], v[96:111]
  ds_read_b64_tr_b16 v[38:39], v9 offset:9216
  ds_read_b128 v[44:47], v12 offset:4096
  v_mfma_f32_32x32x16_bf16 v[112:127], v[52:55], v[60:63], v[112:127]
  v_mfma_f32_16x16x32_bf16 v[20:23], v[48:51], v[16:19], v[20:23]
  s_waitcnt lgkmcnt(3)
  v_mfma_f32_32x32x16_bf16 v[64:79], v[32:35], v[40:43], v[64:79]
  ds_read_b64_tr_b16 v[48:49], v8 offset:12288
  ds_read_b64_tr_b16 v[50:51], v8 offset:13312
  s_waitcnt lgkmcnt(3)
  v_mfma_f32_32x32x16_bf16 v[80:95], v[36:39], v[40:43], v[80:95]
  ds_read_b128 v[56:59], v13 offset:0
  ds_read_b64_tr_b16 v[52:53], v9 offset:12288
  s_waitcnt lgkmcnt(4)
  v_mfma_f32_32x32x16_bf16 v[96:111], v[32:35], v[44:47], v[96:111]
  ds_read_b64_tr_b16 v[54:55], v9 offset:13312
  ds_read_b128 v[60:63], v13 offset:4096
  v_mfma_f32_32x32x16_bf16 v[112:127], v[36:39], v[44:47], v[112:127]
  v_mfma_f32_16x16x32_bf16 v[20:23], v[32:35], v[16:19], v[20:23]
  s_waitcnt lgkmcnt(3)
  v_mfma_f32_32x32x16_bf16 v[64:79], v[48:51], v[56:59], v[64:79]
  v_add_u32 v8, s31, v2
  v_add_u32 v9, s31, v3
  v_add_u32 v10, s31, v4
  s_barrier
  ds_read_b64_tr_b16 v[32:33], v8 offset:0
  ds_read_b64_tr_b16 v[34:35], v8 offset:1024
  s_waitcnt lgkmcnt(3)
  v_mfma_f32_32x32x16_bf16 v[80:95], v[52:55], v[56:59], v[80:95]
  ds_read_b128 v[40:43], v10 offset:0
  ds_read_b64_tr_b16 v[36:37], v9 offset:0
  v_add_u32 v11, s31, v5
  v_add_u32 v12, s31, v6
  v_add_u32 v13, s31, v7
  s_waitcnt lgkmcnt(4)
  v_mfma_f32_32x32x16_bf16 v[96:111], v[48:51], v[60:63], v[96:111]
  ds_read_b64_tr_b16 v[38:39], v9 offset:1024
  ds_read_b128 v[44:47], v10 offset:4096
  s_add_u32 s31, s31, 32768
  s_cmp_eq_u32 s31, 163840
  s_cselect_b32 s31, 0, s31
  v_mfma_f32_32x32x16_bf16 v[112:127], v[52:55], v[60:63], v[112:127]
  s_add_u32 s27, s27, 1
  s_cmp_lt_u32 s27, 10
  v_mfma_f32_16x16x32_bf16 v[20:23], v[48:51], v[16:19], v[20:23]
  s_cbranch_scc1 La_loop_q
  v_and_b32 v24, 15, v1
  v_lshrrev_b32 v25, 4, v1
  v_lshlrev_b32 v25, 2, v25
  v_lshl_add_u32 v25, v24, 4, v25
  s_lshl_b32 s33, s24, 6
  s_lshl_b32 s34, s23, 5
  s_add_u32 s33, s33, s34
  v_add_lshl_u32 v25, v25, s33, 2
  v_add_u32 v25, 96768, v25
  v_cmp_gt_u32 vcc, 2, v24
  s_nop 3
  s_and_saveexec_b64 s[36:37], vcc
  ds_write_b128 v25, v[20:23] offset:1024
  s_mov_b64 exec, s[36:37]
  v_and_b32 v24, 31, v1
  v_lshrrev_b32 v25, 5, v1
  v_lshlrev_b32 v25, 2, v25
  s_lshl_b32 s33, s23, 6
  s_add_u32 s34, s33, 32
  s_lshl_b32 s35, s24, 6
  s_lshl_b32 s37, s23, 5
  s_add_u32 s35, s35, s37
  s_xor_b32 s36, s35, 32
  v_add_lshl_u32 v26, v24, s33, 2
  v_add_lshl_u32 v28, v25, s35, 2
  v_add_u32 v26, 96768, v26
  v_add_u32 v28, 96768, v28
  v_add_lshl_u32 v27, v24, s34, 2
  v_add_lshl_u32 v29, v25, s36, 2
  v_add_u32 v27, 96768, v27
  v_add_u32 v29, 96768, v29
  s_waitcnt lgkmcnt(0)
  s_barrier
  ds_read_b32 v128, v26 offset:0
  ds_read_b32 v130, v26 offset:512
  ds_read_b32 v132, v27 offset:0
  ds_read_b32 v134, v27 offset:512
  ds_read_b128 v[136:139], v28 offset:1024
  ds_read_b128 v[140:143], v28 offset:1056
  ds_read_b128 v[144:147], v28 offset:1088
  ds_read_b128 v[148:151], v28 offset:1120
  ds_read_b128 v[152:155], v29 offset:1024
  ds_read_b128 v[156:159], v29 offset:1056
  ds_read_b128 v[160:163], v29 offset:1088
  ds_read_b128 v[164:167], v29 offset:1120
  v_add_u32 v26, s33, v24
  v_mul_u32_u24 v26, 272, v26
  v_add_u32 v26, 98304, v26
  v_add_lshl_u32 v28, v25, s35, 1
  v_add_u32 v27, s34, v24
  v_mul_u32_u24 v27, 272, v27
  v_add_u32 v27, 98304, v27
  v_add_lshl_u32 v29, v25, s36, 1
  s_waitcnt lgkmcnt(0)
  v_add_u32 v30, v26, v28
  v_pk_fma_f32 v[64:65], v[136:137], v[128:129], v[64:65] op_sel_hi:[1,0,1] neg_lo:[0,1,0] neg_hi:[0,1,0]
  v_pk_mul_f32 v[64:65], v[64:65], v[130:131] op_sel_hi:[1,0]
  v_pk_fma_f32 v[66:67], v[138:139], v[128:129], v[66:67] op_sel_hi:[1,0,1] neg_lo:[0,1,0] neg_hi:[0,1,0]
  v_pk_mul_f32 v[66:67], v[66:67], v[130:131] op_sel_hi:[1,0]
  v_cvt_pk_bf16_f32 v64, v64, v65
  v_cvt_pk_bf16_f32 v65, v66, v67
  ds_write_b64 v200, v[64:65]
  v_pk_fma_f32 v[68:69], v[140:141], v[128:129], v[68:69] op_sel_hi:[1,0,1] neg_lo:[0,1,0] neg_hi:[0,1,0]
  v_pk_mul_f32 v[68:69], v[68:69], v[130:131] op_sel_hi:[1,0]
  v_pk_fma_f32 v[70:71], v[142:143], v[128:129], v[70:71] op_sel_hi:[1,0,1] neg_lo:[0,1,0] neg_hi:[0,1,0]
  v_pk_mul_f32 v[70:71], v[70:71], v[130:131] op_sel_hi:[1,0]
  v_cvt_pk_bf16_f32 v68, v68, v69
  v_cvt_pk_bf16_f32 v69, v70, v71
  ds_write_b64 v201, v[68:69]
  v_pk_fma_f32 v[72:73], v[144:145], v[128:129], v[72:73] op_sel_hi:[1,0,1] neg_lo:[0,1,0] neg_hi:[0,1,0]
  v_pk_mul_f32 v[72:73], v[72:73], v[130:131] op_sel_hi:[1,0]
  v_pk_fma_f32 v[74:75], v[146:147], v[128:129], v[74:75] op_sel_hi:[1,0,1] neg_lo:[0,1,0] neg_hi:[0,1,0]
  v_pk_mul_f32 v[74:75], v[74:75], v[130:131] op_sel_hi:[1,0]
  v_cvt_pk_bf16_f32 v72, v72, v73
  v_cvt_pk_bf16_f32 v73, v74, v75
  ds_write_b64 v202, v[72:73]
  v_pk_fma_f32 v[76:77], v[148:149], v[128:129], v[76:77] op_sel_hi:[1,0,1] neg_lo:[0,1,0] neg_hi:[0,1,0]
  v_pk_mul_f32 v[76:77], v[76:77], v[130:131] op_sel_hi:[1,0]
  v_pk_fma_f32 v[78:79], v[150:151], v[128:129], v[78:79] op_sel_hi:[1,0,1] neg_lo:[0,1,0] neg_hi:[0,1,0]
  v_pk_mul_f32 v[78:79], v[78:79], v[130:131] op_sel_hi:[1,0]
  v_cvt_pk_bf16_f32 v76, v76, v77
  v_cvt_pk_bf16_f32 v77, v78, v79
  ds_write_b64 v203, v[76:77]
  v_add_u32 v30, v26, v29
  v_pk_fma_f32 v[80:81], v[152:153], v[128:129], v[80:81] op_sel_hi:[1,0,1] neg_lo:[0,1,0] neg_hi:[0,1,0]
  v_pk_mul_f32 v[80:81], v[80:81], v[130:131] op_sel_hi:[1,0]
  v_pk_fma_f32 v[82:83], v[154:155], v[128:129], v[82:83] op_sel_hi:[1,0,1] neg_lo:[0,1,0] neg_hi:[0,1,0]
  v_pk_mul_f32 v[82:83], v[82:83], v[130:131] op_sel_hi:[1,0]
  v_cvt_pk_bf16_f32 v80, v80, v81
  v_cvt_pk_bf16_f32 v81, v82, v83
  ds_write_b64 v204, v[80:81]
  v_pk_fma_f32 v[84:85], v[156:157], v[128:129], v[84:85] op_sel_hi:[1,0,1] neg_lo:[0,1,0] neg_hi:[0,1,0]
  v_pk_mul_f32 v[84:85], v[84:85], v[130:131] op_sel_hi:[1,0]
  v_pk_fma_f32 v[86:87], v[158:159], v[128:129], v[86:87] op_sel_hi:[1,0,1] neg_lo:[0,1,0] neg_hi:[0,1,0]
  v_pk_mul_f32 v[86:87], v[86:87], v[130:131] op_sel_hi:[1,0]
  v_cvt_pk_bf16_f32 v84, v84, v85
  v_cvt_pk_bf16_f32 v85, v86, v87
  ds_write_b64 v205, v[84:85]
  v_pk_fma_f32 v[88:89], v[160:161], v[128:129], v[88:89] op_sel_hi:[1,0,1] neg_lo:[0,1,0] neg_hi:[0,1,0]
  v_pk_mul_f32 v[88:89], v[88:89], v[130:131] op_sel_hi:[1,0]
  v_pk_fma_f32 v[90:91], v[162:163], v[128:129], v[90:91] op_sel_hi:[1,0,1] neg_lo:[0,1,0] neg_hi:[0,1,0]
  v_pk_mul_f32 v[90:91], v[90:91], v[130:131] op_sel_hi:[1,0]
  v_cvt_pk_bf16_f32 v88, v88, v89
  v_cvt_pk_bf16_f32 v89, v90, v91
  ds_write_b64 v206, v[88:89]
  v_pk_fma_f32 v[92:93], v[164:165], v[128:129], v[92:93] op_sel_hi:[1,0,1] neg_lo:[0,1,0] neg_hi:[0,1,0]
  v_pk_mul_f32 v[92:93], v[92:93], v[130:131] op_sel_hi:[1,0]
  v_pk_fma_f32 v[94:95], v[166:167], v[128:129], v[94:95] op_sel_hi:[1,0,1] neg_lo:[0,1,0] neg_hi:[0,1,0]
  v_pk_mul_f32 v[94:95], v[94:95], v[130:131] op_sel_hi:[1,0]
  v_cvt_pk_bf16_f32 v92, v92, v93
  v_cvt_pk_bf16_f32 v93, v94, v95
  ds_write_b64 v207, v[92:93]
  v_add_u32 v30, v27, v28
  v_pk_fma_f32 v[96:97], v[136:137], v[132:133], v[96:97] op_sel_hi:[1,0,1] neg_lo:[0,1,0] neg_hi:[0,1,0]
  v_pk_mul_f32 v[96:97], v[96:97], v[134:135] op_sel_hi:[1,0]
  v_pk_fma_f32 v[98:99], v[138:139], v[132:133], v[98:99] op_sel_hi:[1,0,1] neg_lo:[0,1,0] neg_hi:[0,1,0]
  v_pk_mul_f32 v[98:99], v[98:99], v[134:135] op_sel_hi:[1,0]
  v_cvt_pk_bf16_f32 v96, v96, v97
  v_cvt_pk_bf16_f32 v97, v98, v99
  ds_write_b64 v208, v[96:97]
  v_pk_fma_f32 v[100:101], v[140:141], v[132:133], v[100:101] op_sel_hi:[1,0,1] neg_lo:[0,1,0] neg_hi:[0,1,0]
  v_pk_mul_f32 v[100:101], v[100:101], v[134:135] op_sel_hi:[1,0]
  v_pk_fma_f32 v[102:103], v[142:143], v[132:133], v[102:103] op_sel_hi:[1,0,1] neg_lo:[0,1,0] neg_hi:[0,1,0]
  v_pk_mul_f32 v[102:103], v[102:103], v[134:135] op_sel_hi:[1,0]
  v_cvt_pk_bf16_f32 v100, v100, v101
  v_cvt_pk_bf16_f32 v101, v102, v103
  ds_write_b64 v209, v[100:101]
  v_pk_fma_f32 v[104:105], v[144:145], v[132:133], v[104:105] op_sel_hi:[1,0,1] neg_lo:[0,1,0] neg_hi:[0,1,0]
  v_pk_mul_f32 v[104:105], v[104:105], v[134:135] op_sel_hi:[1,0]
  v_pk_fma_f32 v[106:107], v[146:147], v[132:133], v[106:107] op_sel_hi:[1,0,1] neg_lo:[0,1,0] neg_hi:[0,1,0]
  v_pk_mul_f32 v[106:107], v[106:107], v[134:135] op_sel_hi:[1,0]
  v_cvt_pk_bf16_f32 v104, v104, v105
  v_cvt_pk_bf16_f32 v105, v106, v107
  ds_write_b64 v210, v[104:105]
  v_pk_fma_f32 v[108:109], v[148:149], v[132:133], v[108:109] op_sel_hi:[1,0,1] neg_lo:[0,1,0] neg_hi:[0,1,0]
  v_pk_mul_f32 v[108:109], v[108:109], v[134:135] op_sel_hi:[1,0]
  v_pk_fma_f32 v[110:111], v[150:151], v[132:133], v[110:111] op_sel_hi:[1,0,1] neg_lo:[0,1,0] neg_hi:[0,1,0]
  v_pk_mul_f32 v[110:111], v[110:111], v[134:135] op_sel_hi:[1,0]
  v_cvt_pk_bf16_f32 v108, v108, v109
  v_cvt_pk_bf16_f32 v109, v110, v111
  ds_write_b64 v211, v[108:109]
  v_add_u32 v30, v27, v29
  v_pk_fma_f32 v[112:113], v[152:153], v[132:133], v[112:113] op_sel_hi:[1,0,1] neg_lo:[0,1,0] neg_hi:[0,1,0]
  v_pk_mul_f32 v[112:113], v[112:113], v[134:135] op_sel_hi:[1,0]
  v_pk_fma_f32 v[114:115], v[154:155], v[132:133], v[114:115] op_sel_hi:[1,0,1] neg_lo:[0,1,0] neg_hi:[0,1,0]
  v_pk_mul_f32 v[114:115], v[114:115], v[134:135] op_sel_hi:[1,0]
  v_cvt_pk_bf16_f32 v112, v112, v113
  v_cvt_pk_bf16_f32 v113, v114, v115
  ds_write_b64 v212, v[112:113]
  v_pk_fma_f32 v[116:117], v[156:157], v[132:133], v[116:117] op_sel_hi:[1,0,1] neg_lo:[0,1,0] neg_hi:[0,1,0]
  v_pk_mul_f32 v[116:117], v[116:117], v[134:135] op_sel_hi:[1,0]
  v_pk_fma_f32 v[118:119], v[158:159], v[132:133], v[118:119] op_sel_hi:[1,0,1] neg_lo:[0,1,0] neg_hi:[0,1,0]
  v_pk_mul_f32 v[118:119], v[118:119], v[134:135] op_sel_hi:[1,0]
  v_cvt_pk_bf16_f32 v116, v116, v117
  v_cvt_pk_bf16_f32 v117, v118, v119
  ds_write_b64 v213, v[116:117]
  v_pk_fma_f32 v[120:121], v[160:161], v[132:133], v[120:121] op_sel_hi:[1,0,1] neg_lo:[0,1,0] neg_hi:[0,1,0]
  v_pk_mul_f32 v[120:121], v[120:121], v[134:135] op_sel_hi:[1,0]
  v_pk_fma_f32 v[122:123], v[162:163], v[132:133], v[122:123] op_sel_hi:[1,0,1] neg_lo:[0,1,0] neg_hi:[0,1,0]
  v_pk_mul_f32 v[122:123], v[122:123], v[134:135] op_sel_hi:[1,0]
  v_cvt_pk_bf16_f32 v120, v120, v121
  v_cvt_pk_bf16_f32 v121, v122, v123
  ds_write_b64 v214, v[120:121]
  v_pk_fma_f32 v[124:125], v[164:165], v[132:133], v[124:125] op_sel_hi:[1,0,1] neg_lo:[0,1,0] neg_hi:[0,1,0]
  v_pk_mul_f32 v[124:125], v[124:125], v[134:135] op_sel_hi:[1,0]
  v_pk_fma_f32 v[126:127], v[166:167], v[132:133], v[126:127] op_sel_hi:[1,0,1] neg_lo:[0,1,0] neg_hi:[0,1,0]
  v_pk_mul_f32 v[126:127], v[126:127], v[134:135] op_sel_hi:[1,0]
  v_cvt_pk_bf16_f32 v124, v124, v125
  v_cvt_pk_bf16_f32 v125, v126, v127
  ds_write_b64 v215, v[124:125]
  v_lshlrev_b32 v217, 11, v1
  v_add_u32 v217, 16271232, v217
  s_mov_b64 exec, 0xffff
  buffer_load_dword v216, v217, s[44:47], 0 offen sc1
  s_mov_b64 exec, -1
  s_branch La_store
La_v:
  ds_read_b64_tr_b16 v[32:33], v8 offset:0
  ds_read_b64_tr_b16 v[34:35], v8 offset:1024
  ds_read_b128 v[40:43], v10 offset:0
  ds_read_b64_tr_b16 v[36:37], v9 offset:0
  ds_read_b64_tr_b16 v[38:39], v9 offset:1024
  ds_read_b128 v[44:47], v10 offset:4096
La_loop_v:
  s_waitcnt lgkmcnt(3)
  v_mfma_f32_32x32x16_bf16 v[64:79], v[40:43], v[32:35], v[64:79]
  s_cmp_eq_u32 s27, s60
  s_cbranch_scc0 La_nopf_v
  buffer_load_dword v221, v224, s[48:51], 0 offen
  buffer_load_dword v222, v225, s[48:51], 0 offen
  buffer_load_dword v221, v226, s[48:51], 0 offen
  buffer_load_dword v222, v227, s[48:51], 0 offen
  buffer_load_dword v221, v228, s[48:51], 0 offen
  buffer_load_dword v222, v229, s[48:51], 0 offen
  buffer_load_dword v221, v230, s[48:51], 0 offen
  v_lshlrev_b32 v220, 7, v1
  buffer_load_dword v221, v220, s[56:59], 0 offen
  buffer_load_dword v222, v220, s[64:67], 0 offen
  v_lshlrev_b32 v220, 20, v1
  buffer_load_dword v221, v220, s[44:47], 0 offen sc1
  buffer_load_dword v222, v220, s[92:95], 0 offen
La_nopf_v:
  ds_read_b64_tr_b16 v[48:49], v8 offset:4096
  ds_read_b64_tr_b16 v[50:51], v8 offset:5120
  s_waitcnt lgkmcnt(3)
  v_mfma_f32_32x32x16_bf16 v[80:95], v[40:43], v[36:39], v[80:95]
  ds_read_b128 v[56:59], v11 offset:0
  ds_read_b64_tr_b16 v[52:53], v9 offset:4096
  s_waitcnt lgkmcnt(4)
  v_mfma_f32_32x32x16_bf16 v[96:111], v[44:47], v[32:35], v[96:111]
  ds_read_b64_tr_b16 v[54:55], v9 offset:5120
  ds_read_b128 v[60:63], v11 offset:4096
  v_mfma_f32_32x32x16_bf16 v[112:127], v[44:47], v[36:39], v[112:127]
  v_mfma_f32_16x16x32_bf16 v[20:23], v[32:35], v[16:19], v[20:23]
  s_waitcnt lgkmcnt(3)
  v_mfma_f32_32x32x16_bf16 v[64:79], v[56:59], v[48:51], v[64:79]
  ds_read_b64_tr_b16 v[32:33], v8 offset:8192
  ds_read_b64_tr_b16 v[34:35], v8 offset:9216
  s_waitcnt lgkmcnt(3)
  v_mfma_f32_32x32x16_bf16 v[80:95], v[56:59], v[52:55], v[80:95]
  ds_read_b128 v[40:43], v12 offset:0
  ds_read_b64_tr_b16 v[36:37], v9 offset:8192
  s_waitcnt lgkmcnt(4)
  v_mfma_f32_32x32x16_bf16 v[96:111], v[60:63], v[48:51], v[96:111]
  ds_read_b64_tr_b16 v[38:39], v9 offset:9216
  ds_read_b128 v[44:47], v12 offset:4096
  v_mfma_f32_32x32x16_bf16 v[112:127], v[60:63], v[52:55], v[112:127]
  v_mfma_f32_16x16x32_bf16 v[20:23], v[48:51], v[16:19], v[20:23]
  s_waitcnt lgkmcnt(3)
  v_mfma_f32_32x32x16_bf16 v[64:79], v[40:43], v[32:35], v[64:79]
  ds_read_b64_tr_b16 v[48:49], v8 offset:12288
  ds_read_b64_tr_b16 v[50:51], v8 offset:13312
  s_waitcnt lgkmcnt(3)
  v_mfma_f32_32x32x16_bf16 v[80:95], v[40:43], v[36:39], v[80:95]
  ds_read_b128 v[56:59], v13 offset:0
  ds_read_b64_tr_b16 v[52:53], v9 offset:12288
  s_waitcnt lgkmcnt(4)
  v_mfma_f32_32x32x16_bf16 v[96:111], v[44:47], v[32:35], v[96:111]
  ds_read_b64_tr_b16 v[54:55], v9 offset:13312
  ds_read_b128 v[60:63], v13 offset:4096
  v_mfma_f32_32x32x16_bf16 v[112:127], v[44:47], v[36:39], v[112:127]
  v_mfma_f32_16x16x32_bf16 v[20:23], v[32:35], v[16:19], v[20:23]
  s_waitcnt lgkmcnt(3)
  v_mfma_f32_32x32x16_bf16 v[64:79], v[56:59], v[48:51], v[64:79]
  v_add_u32 v8, s31, v2
  v_add_u32 v9, s31, v3
  v_add_u32 v10, s31, v4
  s_barrier
  ds_read_b64_tr_b16 v[32:33], v8 offset:0
  ds_read_b64_tr_b16 v[34:35], v8 offset:1024
  s_waitcnt lgkmcnt(3)
  v_mfma_f32_32x32x16_bf16 v[80:95], v[56:59], v[52:55], v[80:95]
  ds_read_b128 v[40:43], v10 offset:0
  ds_read_b64_tr_b16 v[36:37], v9 offset:0
  v_add_u32 v11, s31, v5
  v_add_u32 v12, s31, v6
  v_add_u32 v13, s31, v7
  s_waitcnt lgkmcnt(4)
  v_mfma_f32_32x32x16_bf16 v[96:111], v[60:63], v[48:51], v[96:111]
  ds_read_b64_tr_b16 v[38:39], v9 offset:1024
  ds_read_b128 v[44:47], v10 offset:4096
  s_add_u32 s31, s31, 32768
  s_cmp_eq_u32 s31, 163840
  s_cselect_b32 s31, 0, s31
  v_mfma_f32_32x32x16_bf16 v[112:127], v[60:63], v[52:55], v[112:127]
  s_add_u32 s27, s27, 1
  s_cmp_lt_u32 s27, 10
  v_mfma_f32_16x16x32_bf16 v[20:23], v[48:51], v[16:19], v[20:23]
  s_cbranch_scc1 La_loop_v
  v_and_b32 v24, 15, v1
  v_lshrrev_b32 v25, 4, v1
  v_lshlrev_b32 v25, 2, v25
  v_lshl_add_u32 v25, v24, 4, v25
  s_lshl_b32 s33, s24, 6
  s_lshl_b32 s34, s23, 5
  s_add_u32 s33, s33, s34
  v_add_lshl_u32 v25, v25, s33, 2
  v_add_u32 v25, 96768, v25
  v_cmp_gt_u32 vcc, 2, v24
  s_nop 3
  s_and_saveexec_b64 s[36:37], vcc
  ds_write_b128 v25, v[20:23] offset:1024
  s_mov_b64 exec, s[36:37]
  v_and_b32 v24, 31, v1
  v_lshrrev_b32 v25, 5, v1
  v_lshlrev_b32 v25, 2, v25
  s_lshl_b32 s33, s23, 6
  s_add_u32 s34, s33, 32
  s_lshl_b32 s35, s24, 6
  s_lshl_b32 s37, s23, 5
  s_add_u32 s35, s35, s37
  s_xor_b32 s36, s35, 32
  v_add_lshl_u32 v26, v24, s35, 2
  v_add_lshl_u32 v28, v25, s33, 2
  v_add_u32 v26, 96768, v26
  v_add_u32 v28, 96768, v28
  v_add_lshl_u32 v27, v24, s36, 2
  v_add_lshl_u32 v29, v25, s34, 2
  v_add_u32 v27, 96768, v27
  v_add_u32 v29, 96768, v29
  s_waitcnt lgkmcnt(0)
  s_barrier
  ds_read_b32 v128, v26 offset:1024
  ds_read_b32 v132, v27 offset:1024
  ds_read_b128 v[136:139], v28 offset:0
  ds_read_b128 v[152:155], v28 offset:512
  ds_read_b128 v[140:143], v28 offset:32
  ds_read_b128 v[156:159], v28 offset:544
  ds_read_b128 v[144:147], v28 offset:64
  ds_read_b128 v[160:163], v28 offset:576
  ds_read_b128 v[148:151], v28 offset:96
  ds_read_b128 v[164:167], v28 offset:608
  ds_read_b128 v[168:171], v29 offset:0
  ds_read_b128 v[184:187], v29 offset:512
  ds_read_b128 v[172:175], v29 offset:32
  ds_read_b128 v[188:191], v29 offset:544
  ds_read_b128 v[176:179], v29 offset:64
  ds_read_b128 v[192:195], v29 offset:576
  ds_read_b128 v[180:183], v29 offset:96
  ds_read_b128 v[196:199], v29 offset:608
  v_add_u32 v26, s35, v24
  v_mul_u32_u24 v26, 272, v26
  v_add_u32 v26, 98304, v26
  v_add_lshl_u32 v28, v25, s33, 1
  v_add_u32 v27, s36, v24
  v_mul_u32_u24 v27, 272, v27
  v_add_u32 v27, 98304, v27
  v_add_lshl_u32 v29, v25, s34, 1
  s_waitcnt lgkmcnt(0)
  v_add_u32 v30, v26, v28
  v_pk_fma_f32 v[64:65], v[136:137], v[128:129], v[64:65] op_sel_hi:[1,0,1] neg_lo:[1,0,0] neg_hi:[1,0,0]
  v_pk_mul_f32 v[64:65], v[64:65], v[152:153]
  v_pk_fma_f32 v[66:67], v[138:139], v[128:129], v[66:67] op_sel_hi:[1,0,1] neg_lo:[1,0,0] neg_hi:[1,0,0]
  v_pk_mul_f32 v[66:67], v[66:67], v[154:155]
  v_cvt_pk_bf16_f32 v64, v64, v65
  v_cvt_pk_bf16_f32 v65, v66, v67
  ds_write_b64 v30, v[64:65] offset:0
  v_pk_fma_f32 v[68:69], v[140:141], v[128:129], v[68:69] op_sel_hi:[1,0,1] neg_lo:[1,0,0] neg_hi:[1,0,0]
  v_pk_mul_f32 v[68:69], v[68:69], v[156:157]
  v_pk_fma_f32 v[70:71], v[142:143], v[128:129], v[70:71] op_sel_hi:[1,0,1] neg_lo:[1,0,0] neg_hi:[1,0,0]
  v_pk_mul_f32 v[70:71], v[70:71], v[158:159]
  v_cvt_pk_bf16_f32 v68, v68, v69
  v_cvt_pk_bf16_f32 v69, v70, v71
  ds_write_b64 v30, v[68:69] offset:16
  v_pk_fma_f32 v[72:73], v[144:145], v[128:129], v[72:73] op_sel_hi:[1,0,1] neg_lo:[1,0,0] neg_hi:[1,0,0]
  v_pk_mul_f32 v[72:73], v[72:73], v[160:161]
  v_pk_fma_f32 v[74:75], v[146:147], v[128:129], v[74:75] op_sel_hi:[1,0,1] neg_lo:[1,0,0] neg_hi:[1,0,0]
  v_pk_mul_f32 v[74:75], v[74:75], v[162:163]
  v_cvt_pk_bf16_f32 v72, v72, v73
  v_cvt_pk_bf16_f32 v73, v74, v75
  ds_write_b64 v30, v[72:73] offset:32
  v_pk_fma_f32 v[76:77], v[148:149], v[128:129], v[76:77] op_sel_hi:[1,0,1] neg_lo:[1,0,0] neg_hi:[1,0,0]
  v_pk_mul_f32 v[76:77], v[76:77], v[164:165]
  v_pk_fma_f32 v[78:79], v[150:151], v[128:129], v[78:79] op_sel_hi:[1,0,1] neg_lo:[1,0,0] neg_hi:[1,0,0]
  v_pk_mul_f32 v[78:79], v[78:79], v[166:167]
  v_cvt_pk_bf16_f32 v76, v76, v77
  v_cvt_pk_bf16_f32 v77, v78, v79
  ds_write_b64 v30, v[76:77] offset:48
  v_add_u32 v30, v27, v28
  v_pk_fma_f32 v[80:81], v[136:137], v[132:133], v[80:81] op_sel_hi:[1,0,1] neg_lo:[1,0,0] neg_hi:[1,0,0]
  v_pk_mul_f32 v[80:81], v[80:81], v[152:153]
  v_pk_fma_f32 v[82:83], v[138:139], v[132:133], v[82:83] op_sel_hi:[1,0,1] neg_lo:[1,0,0] neg_hi:[1,0,0]
  v_pk_mul_f32 v[82:83], v[82:83], v[154:155]
  v_cvt_pk_bf16_f32 v80, v80, v81
  v_cvt_pk_bf16_f32 v81, v82, v83
  ds_write_b64 v30, v[80:81] offset:0
  v_pk_fma_f32 v[84:85], v[140:141], v[132:133], v[84:85] op_sel_hi:[1,0,1] neg_lo:[1,0,0] neg_hi:[1,0,0]
  v_pk_mul_f32 v[84:85], v[84:85], v[156:157]
  v_pk_fma_f32 v[86:87], v[142:143], v[132:133], v[86:87] op_sel_hi:[1,0,1] neg_lo:[1,0,0] neg_hi:[1,0,0]
  v_pk_mul_f32 v[86:87], v[86:87], v[158:159]
  v_cvt_pk_bf16_f32 v84, v84, v85
  v_cvt_pk_bf16_f32 v85, v86, v87
  ds_write_b64 v30, v[84:85] offset:16
  v_pk_fma_f32 v[88:89], v[144:145], v[132:133], v[88:89] op_sel_hi:[1,0,1] neg_lo:[1,0,0] neg_hi:[1,0,0]
  v_pk_mul_f32 v[88:89], v[88:89], v[160:161]
  v_pk_fma_f32 v[90:91], v[146:147], v[132:133], v[90:91] op_sel_hi:[1,0,1] neg_lo:[1,0,0] neg_hi:[1,0,0]
  v_pk_mul_f32 v[90:91], v[90:91], v[162:163]
  v_cvt_pk_bf16_f32 v88, v88, v89
  v_cvt_pk_bf16_f32 v89, v90, v91
  ds_write_b64 v30, v[88:89] offset:32
  v_pk_fma_f32 v[92:93], v[148:149], v[132:133], v[92:93] op_sel_hi:[1,0,1] neg_lo:[1,0,0] neg_hi:[1,0,0]
  v_pk_mul_f32 v[92:93], v[92:93], v[164:165]
  v_pk_fma_f32 v[94:95], v[150:151], v[132:133], v[94:95] op_sel_hi:[1,0,1] neg_lo:[1,0,0] neg_hi:[1,0,0]
  v_pk_mul_f32 v[94:95], v[94:95], v[166:167]
  v_cvt_pk_bf16_f32 v92, v92, v93
  v_cvt_pk_bf16_f32 v93, v94, v95
  ds_write_b64 v30, v[92:93] offset:48
  v_add_u32 v30, v26, v29
  v_pk_fma_f32 v[96:97], v[168:169], v[128:129], v[96:97] op_sel_hi:[1,0,1] neg_lo:[1,0,0] neg_hi:[1,0,0]
  v_pk_mul_f32 v[96:97], v[96:97], v[184:185]
  v_pk_fma_f32 v[98:99], v[170:171], v[128:129], v[98:99] op_sel_hi:[1,0,1] neg_lo:[1,0,0] neg_hi:[1,0,0]
  v_pk_mul_f32 v[98:99], v[98:99], v[186:187]
  v_cvt_pk_bf16_f32 v96, v96, v97
  v_cvt_pk_bf16_f32 v97, v98, v99
  ds_write_b64 v30, v[96:97] offset:0
  v_pk_fma_f32 v[100:101], v[172:173], v[128:129], v[100:101] op_sel_hi:[1,0,1] neg_lo:[1,0,0] neg_hi:[1,0,0]
  v_pk_mul_f32 v[100:101], v[100:101], v[188:189]
  v_pk_fma_f32 v[102:103], v[174:175], v[128:129], v[102:103] op_sel_hi:[1,0,1] neg_lo:[1,0,0] neg_hi:[1,0,0]
  v_pk_mul_f32 v[102:103], v[102:103], v[190:191]
  v_cvt_pk_bf16_f32 v100, v100, v101
  v_cvt_pk_bf16_f32 v101, v102, v103
  ds_write_b64 v30, v[100:101] offset:16
  v_pk_fma_f32 v[104:105], v[176:177], v[128:129], v[104:105] op_sel_hi:[1,0,1] neg_lo:[1,0,0] neg_hi:[1,0,0]
  v_pk_mul_f32 v[104:105], v[104:105], v[192:193]
  v_pk_fma_f32 v[106:107], v[178:179], v[128:129], v[106:107] op_sel_hi:[1,0,1] neg_lo:[1,0,0] neg_hi:[1,0,0]
  v_pk_mul_f32 v[106:107], v[106:107], v[194:195]
  v_cvt_pk_bf16_f32 v104, v104, v105
  v_cvt_pk_bf16_f32 v105, v106, v107
  ds_write_b64 v30, v[104:105] offset:32
  v_pk_fma_f32 v[108:109], v[180:181], v[128:129], v[108:109] op_sel_hi:[1,0,1] neg_lo:[1,0,0] neg_hi:[1,0,0]
  v_pk_mul_f32 v[108:109], v[108:109], v[196:197]
  v_pk_fma_f32 v[110:111], v[182:183], v[128:129], v[110:111] op_sel_hi:[1,0,1] neg_lo:[1,0,0] neg_hi:[1,0,0]
  v_pk_mul_f32 v[110:111], v[110:111], v[198:199]
  v_cvt_pk_bf16_f32 v108, v108, v109
  v_cvt_pk_bf16_f32 v109, v110, v111
  ds_write_b64 v30, v[108:109] offset:48
  v_add_u32 v30, v27, v29
  v_pk_fma_f32 v[112:113], v[168:169], v[132:133], v[112:113] op_sel_hi:[1,0,1] neg_lo:[1,0,0] neg_hi:[1,0,0]
  v_pk_mul_f32 v[112:113], v[112:113], v[184:185]
  v_pk_fma_f32 v[114:115], v[170:171], v[132:133], v[114:115] op_sel_hi:[1,0,1] neg_lo:[1,0,0] neg_hi:[1,0,0]
  v_pk_mul_f32 v[114:115], v[114:115], v[186:187]
  v_cvt_pk_bf16_f32 v112, v112, v113
  v_cvt_pk_bf16_f32 v113, v114, v115
  ds_write_b64 v30, v[112:113] offset:0
  v_pk_fma_f32 v[116:117], v[172:173], v[132:133], v[116:117] op_sel_hi:[1,0,1] neg_lo:[1,0,0] neg_hi:[1,0,0]
  v_pk_mul_f32 v[116:117], v[116:117], v[188:189]
  v_pk_fma_f32 v[118:119], v[174:175], v[132:133], v[118:119] op_sel_hi:[1,0,1] neg_lo:[1,0,0] neg_hi:[1,0,0]
  v_pk_mul_f32 v[118:119], v[118:119], v[190:191]
  v_cvt_pk_bf16_f32 v116, v116, v117
  v_cvt_pk_bf16_f32 v117, v118, v119
  ds_write_b64 v30, v[116:117] offset:16
  v_pk_fma_f32 v[120:121], v[176:177], v[132:133], v[120:121] op_sel_hi:[1,0,1] neg_lo:[1,0,0] neg_hi:[1,0,0]
  v_pk_mul_f32 v[120:121], v[120:121], v[192:193]
  v_pk_fma_f32 v[122:123], v[178:179], v[132:133], v[122:123] op_sel_hi:[1,0,1] neg_lo:[1,0,0] neg_hi:[1,0,0]
  v_pk_mul_f32 v[122:123], v[122:123], v[194:195]
  v_cvt_pk_bf16_f32 v120, v120, v121
  v_cvt_pk_bf16_f32 v121, v122, v123
  ds_write_b64 v30, v[120:121] offset:32
  v_pk_fma_f32 v[124:125], v[180:181], v[132:133], v[124:125] op_sel_hi:[1,0,1] neg_lo:[1,0,0] neg_hi:[1,0,0]
  v_pk_mul_f32 v[124:125], v[124:125], v[196:197]
  v_pk_fma_f32 v[126:127], v[182:183], v[132:133], v[126:127] op_sel_hi:[1,0,1] neg_lo:[1,0,0] neg_hi:[1,0,0]
  v_pk_mul_f32 v[126:127], v[126:127], v[198:199]
  v_cvt_pk_bf16_f32 v124, v124, v125
  v_cvt_pk_bf16_f32 v125, v126, v127
  ds_write_b64 v30, v[124:125] offset:48
  v_lshlrev_b32 v217, 11, v1
  v_add_u32 v217, 16271232, v217
  s_mov_b64 exec, 0xffff
  buffer_load_dword v216, v217, s[44:47], 0 offen sc1
  s_mov_b64 exec, -1
  s_branch La_store
La_loader:
  v_lshrrev_b32 v25, 4, v1
  v_and_b32 v26, 15, v1
  s_sub_u32 s35, s22, 4
  v_lshlrev_b32 v27, 2, v25
  v_xor_b32 v27, v27, v26
  s_lshl_b32 s33, s35, 4
  v_add_u32 v28, s33, v25
  v_mul_u32_u24 v28, 3840, v28
  v_lshl_add_u32 v28, v27, 4, v28
  s_lshl_b32 s33, s26, 8
  v_add_u32 v2, s33, v28
  v_add_u32 v3, 14336, v2
  v_add_u32 v4, 28672, v2
  v_add_u32 v5, 43008, v2
  v_lshrrev_b32 v27, 3, v1
  v_and_b32 v28, 7, v1
  s_lshl_b32 s33, s25, 7
  s_lshl_b32 s34, s35, 5
  s_add_u32 s33, s33, s34
  v_add_u32 v29, s33, v27
  v_mul_u32_u24 v29, 1280, v29
  v_xor_b32 v30, v28, v25
  v_xor_b32 v31, 4, v30
  v_lshl_add_u32 v6, v30, 4, v29
  v_lshl_add_u32 v7, v31, 4, v29
  v_add_u32 v8, 18432, v6
  v_add_u32 v9, 27648, v7
  v_add_u32 v7, 9216, v7
  s_lshl_b32 s30, s35, 12
  s_add_u32 s32, s26, s25
  s_mul_i32 s33, s32, 26
  s_lshr_b32 s33, s33, 8
  s_mul_i32 s33, s33, 10
  s_sub_u32 s32, s32, s33
  s_waitcnt lgkmcnt(0)
  s_mov_b32 s8, s4
  s_and_b32 s9, s5, 0xffff
  s_mov_b32 s10, 2621440
  s_mov_b32 s11, 0x20000
  s_mov_b32 s12, s6
  s_and_b32 s13, s7, 0xffff
  s_mov_b32 s14, 2457600
  s_mov_b32 s15, 0x20000
  s_add_u32 m0, s30, 0
  s_mul_i32 s28, s32, 245760
  buffer_load_dwordx4 v2, s[12:15], s28 offen offset:0 lds
  buffer_load_dwordx4 v3, s[12:15], s28 offen offset:1024 lds
  buffer_load_dwordx4 v4, s[12:15], s28 offen offset:2048 lds
  buffer_load_dwordx4 v5, s[12:15], s28 offen offset:3072 lds
  s_add_u32 m0, s30, 16384
  s_lshl_b32 s29, s32, 7
  buffer_load_dwordx4 v6, s[8:11], s29 offen offset:0 lds
  buffer_load_dwordx4 v7, s[8:11], s29 offen offset:1024 lds
  buffer_load_dwordx4 v8, s[8:11], s29 offen offset:2048 lds
  buffer_load_dwordx4 v9, s[8:11], s29 offen offset:3072 lds
  s_add_u32 s32, s32, 1
  s_cmp_eq_u32 s32, 10
  s_cselect_b32 s32, 0, s32
  s_add_u32 m0, s30, 32768
  s_mul_i32 s28, s32, 245760
  buffer_load_dwordx4 v2, s[12:15], s28 offen offset:0 lds
  buffer_load_dwordx4 v3, s[12:15], s28 offen offset:1024 lds
  buffer_load_dwordx4 v4, s[12:15], s28 offen offset:2048 lds
  buffer_load_dwordx4 v5, s[12:15], s28 offen offset:3072 lds
  s_add_u32 m0, s30, 49152
  s_lshl_b32 s29, s32, 7
  buffer_load_dwordx4 v6, s[8:11], s29 offen offset:0 lds
  buffer_load_dwordx4 v7, s[8:11], s29 offen offset:1024 lds
  buffer_load_dwordx4 v8, s[8:11], s29 offen offset:2048 lds
  buffer_load_dwordx4 v9, s[8:11], s29 offen offset:3072 lds
  s_add_u32 s32, s32, 1
  s_cmp_eq_u32 s32, 10
  s_cselect_b32 s32, 0, s32
  s_add_u32 m0, s30, 65536
  s_mul_i32 s28, s32, 245760
  buffer_load_dwordx4 v2, s[12:15], s28 offen offset:0 lds
  buffer_load_dwordx4 v3, s[12:15], s28 offen offset:1024 lds
  buffer_load_dwordx4 v4, s[12:15], s28 offen offset:2048 lds
  buffer_load_dwordx4 v5, s[12:15], s28 offen offset:3072 lds
  s_add_u32 m0, s30, 81920
  s_lshl_b32 s29, s32, 7
  buffer_load_dwordx4 v6, s[8:11], s29 offen offset:0 lds
  buffer_load_dwordx4 v7, s[8:11], s29 offen offset:1024 lds
  buffer_load_dwordx4 v8, s[8:11], s29 offen offset:2048 lds
  buffer_load_dwordx4 v9, s[8:11], s29 offen offset:3072 lds
  s_add_u32 s32, s32, 1
  s_cmp_eq_u32 s32, 10
  s_cselect_b32 s32, 0, s32
  s_mov_b32 s16, s20
  s_and_b32 s17, s21, 0xffff
  s_mov_b32 s18, 16269312
  s_mov_b32 s19, 0x20000
  s_mov_b32 s44, s42
  s_and_b32 s45, s43, 0xffff
  s_mov_b32 s46, 256
  s_mov_b32 s47, 0x20000
  s_cmp_eq_u32 s22, 4
  s_cbranch_scc1 La_loader0
  s_waitcnt vmcnt(16)
  s_barrier
  s_add_u32 m0, s30, 98304
  s_mul_i32 s28, s32, 245760
  buffer_load_dwordx4 v2, s[12:15], s28 offen offset:0 lds
  buffer_load_dwordx4 v3, s[12:15], s28 offen offset:1024 lds
  buffer_load_dwordx4 v4, s[12:15], s28 offen offset:2048 lds
  buffer_load_dwordx4 v5, s[12:15], s28 offen offset:3072 lds
  s_add_u32 m0, s30, 114688
  s_lshl_b32 s29, s32, 7
  buffer_load_dwordx4 v6, s[8:11], s29 offen offset:0 lds
  buffer_load_dwordx4 v7, s[8:11], s29 offen offset:1024 lds
  buffer_load_dwordx4 v8, s[8:11], s29 offen offset:2048 lds
  buffer_load_dwordx4 v9, s[8:11], s29 offen offset:3072 lds
  s_add_u32 s32, s32, 1
  s_cmp_eq_u32 s32, 10
  s_cselect_b32 s32, 0, s32
  s_waitcnt vmcnt(16)
  s_barrier
  s_add_u32 m0, s30, 131072
  s_mul_i32 s28, s32, 245760
  buffer_load_dwordx4 v2, s[12:15], s28 offen offset:0 lds
  buffer_load_dwordx4 v3, s[12:15], s28 offen offset:1024 lds
  buffer_load_dwordx4 v4, s[12:15], s28 offen offset:2048 lds
  buffer_load_dwordx4 v5, s[12:15], s28 offen offset:3072 lds
  s_add_u32 m0, s30, 147456
  s_lshl_b32 s29, s32, 7
  buffer_load_dwordx4 v6, s[8:11], s29 offen offset:0 lds
  buffer_load_dwordx4 v7, s[8:11], s29 offen offset:1024 lds
  buffer_load_dwordx4 v8, s[8:11], s29 offen offset:2048 lds
  buffer_load_dwordx4 v9, s[8:11], s29 offen offset:3072 lds
  s_add_u32 s32, s32, 1
  s_cmp_eq_u32 s32, 10
  s_cselect_b32 s32, 0, s32
  s_waitcnt vmcnt(16)
  s_barrier
  s_add_u32 m0, s30, 0
  s_mul_i32 s28, s32, 245760
  buffer_load_dwordx4 v2, s[12:15], s28 offen offset:0 lds
  buffer_load_dwordx4 v3, s[12:15], s28 offen offset:1024 lds
  buffer_load_dwordx4 v4, s[12:15], s28 offen offset:2048 lds
  buffer_load_dwordx4 v5, s[12:15], s28 offen offset:3072 lds
  s_add_u32 m0, s30, 16384
  s_lshl_b32 s29, s32, 7
  buffer_load_dwordx4 v6, s[8:11], s29 offen offset:0 lds
  buffer_load_dwordx4 v7, s[8:11], s29 offen offset:1024 lds
  buffer_load_dwordx4 v8, s[8:11], s29 offen offset:2048 lds
  buffer_load_dwordx4 v9, s[8:11], s29 offen offset:3072 lds
  s_add_u32 s32, s32, 1
  s_cmp_eq_u32 s32, 10
  s_cselect_b32 s32, 0, s32
  s_waitcnt vmcnt(16)
  s_barrier
  s_add_u32 m0, s30, 32768
  s_mul_i32 s28, s32, 245760
  buffer_load_dwordx4 v2, s[12:15], s28 offen offset:0 lds
  buffer_load_dwordx4 v3, s[12:15], s28 offen offset:1024 lds
  buffer_load_dwordx4 v4, s[12:15], s28 offen offset:2048 lds
  buffer_load_dwordx4 v5, s[12:15], s28 offen offset:3072 lds
  s_add_u32 m0, s30, 49152
  s_lshl_b32 s29, s32, 7
  buffer_load_dwordx4 v6, s[8:11], s29 offen offset:0 lds
  buffer_load_dwordx4 v7, s[8:11], s29 offen offset:1024 lds
  buffer_load_dwordx4 v8, s[8:11], s29 offen offset:2048 lds
  buffer_load_dwordx4 v9, s[8:11], s29 offen offset:3072 lds
  s_add_u32 s32, s32, 1
  s_cmp_eq_u32 s32, 10
  s_cselect_b32 s32, 0, s32
  s_waitcnt vmcnt(16)
  s_barrier
  s_add_u32 m0, s30, 65536
  s_mul_i32 s28, s32, 245760
  buffer_load_dwordx4 v2, s[12:15], s28 offen offset:0 lds
  buffer_load_dwordx4 v3, s[12:15], s28 offen offset:1024 lds
  buffer_load_dwordx4 v4, s[12:15], s28 offen offset:2048 lds
  buffer_load_dwordx4 v5, s[12:15], s28 offen offset:3072 lds
  s_add_u32 m0, s30, 81920
  s_lshl_b32 s29, s32, 7
  buffer_load_dwordx4 v6, s[8:11], s29 offen offset:0 lds
  buffer_load_dwordx4 v7, s[8:11], s29 offen offset:1024 lds
  buffer_load_dwordx4 v8, s[8:11], s29 offen offset:2048 lds
  buffer_load_dwordx4 v9, s[8:11], s29 offen offset:3072 lds
  s_add_u32 s32, s32, 1
  s_cmp_eq_u32 s32, 10
  s_cselect_b32 s32, 0, s32
  s_waitcnt vmcnt(16)
  s_barrier
  s_add_u32 m0, s30, 98304
  s_mul_i32 s28, s32, 245760
  buffer_load_dwordx4 v2, s[12:15], s28 offen offset:0 lds
  buffer_load_dwordx4 v3, s[12:15], s28 offen offset:1024 lds
  buffer_load_dwordx4 v4, s[12:15], s28 offen offset:2048 lds
  buffer_load_dwordx4 v5, s[12:15], s28 offen offset:3072 lds
  s_add_u32 m0, s30, 114688
  s_lshl_b32 s29, s32, 7
  buffer_load_dwordx4 v6, s[8:11], s29 offen offset:0 lds
  buffer_load_dwordx4 v7, s[8:11], s29 offen offset:1024 lds
  buffer_load_dwordx4 v8, s[8:11], s29 offen offset:2048 lds
  buffer_load_dwordx4 v9, s[8:11], s29 offen offset:3072 lds
  s_add_u32 s32, s32, 1
  s_cmp_eq_u32 s32, 10
  s_cselect_b32 s32, 0, s32
  s_waitcnt vmcnt(16)
  s_barrier
  s_add_u32 m0, s30, 131072
  s_mul_i32 s28, s32, 245760
  buffer_load_dwordx4 v2, s[12:15], s28 offen offset:0 lds
  buffer_load_dwordx4 v3, s[12:15], s28 offen offset:1024 lds
  buffer_load_dwordx4 v4, s[12:15], s28 offen offset:2048 lds
  buffer_load_dwordx4 v5, s[12:15], s28 offen offset:3072 lds
  s_add_u32 m0, s30, 147456
  s_lshl_b32 s29, s32, 7
  buffer_load_dwordx4 v6, s[8:11], s29 offen offset:0 lds
  buffer_load_dwordx4 v7, s[8:11], s29 offen offset:1024 lds
  buffer_load_dwordx4 v8, s[8:11], s29 offen offset:2048 lds
  buffer_load_dwordx4 v9, s[8:11], s29 offen offset:3072 lds
  s_add_u32 s32, s32, 1
  s_cmp_eq_u32 s32, 10
  s_cselect_b32 s32, 0, s32
  s_waitcnt vmcnt(16)
  s_barrier
  s_waitcnt vmcnt(8)
  s_barrier
  s_waitcnt vmcnt(0)
  s_barrier
  s_branch La_ltail
La_loader0:
  s_mov_b32 s16, s20
  s_and_b32 s17, s21, 0xffff
  s_mov_b32 s18, 16388096
  s_mov_b32 s19, 0x20000
  v_mov_b32 v28, 16304128
  v_mov_b32 v29, 0
  s_cmp_eq_u32 s2, 0
  s_cbranch_scc0 La_notag
  buffer_load_dword v29, v28, s[16:19], 0 offen sc1
La_notag:
  s_lshl_b32 s33, s25, 2
  s_add_u32 s33, s33, 128
  v_mov_b32 v24, s33
  s_lshl_b32 s34, s25, 10
  s_add_u32 s34, s34, 16252928
  v_lshlrev_b32 v25, 4, v1
  s_waitcnt vmcnt(16)
  s_barrier
  s_add_u32 m0, s30, 98304
  s_mul_i32 s28, s32, 245760
  buffer_load_dwordx4 v2, s[12:15], s28 offen offset:0 lds
  buffer_load_dwordx4 v3, s[12:15], s28 offen offset:1024 lds
  buffer_load_dwordx4 v4, s[12:15], s28 offen offset:2048 lds
  buffer_load_dwordx4 v5, s[12:15], s28 offen offset:3072 lds
  s_add_u32 m0, s30, 114688
  s_lshl_b32 s29, s32, 7
  buffer_load_dwordx4 v6, s[8:11], s29 offen offset:0 lds
  buffer_load_dwordx4 v7, s[8:11], s29 offen offset:1024 lds
  buffer_load_dwordx4 v8, s[8:11], s29 offen offset:2048 lds
  buffer_load_dwordx4 v9, s[8:11], s29 offen offset:3072 lds
  s_add_u32 s32, s32, 1
  s_cmp_eq_u32 s32, 10
  s_cselect_b32 s32, 0, s32
  s_waitcnt vmcnt(16)
  s_barrier
  s_cmp_eq_u32 s2, 0
  s_cbranch_scc0 La_notag2
  s_waitcnt vmcnt(8)
  v_add_u32 v29, 2, v29
  v_or_b32 v29, 1, v29
  v_mov_b32 v30, 64
  s_mov_b64 exec, 1
  buffer_store_dword v29, v30, s[44:47], 0 offen sc1
  buffer_store_dword v29, v28, s[16:19], 0 offen sc1
  s_mov_b64 exec, -1
La_notag2:
  s_add_u32 m0, s30, 131072
  s_mul_i32 s28, s32, 245760
  buffer_load_dwordx4 v2, s[12:15], s28 offen offset:0 lds
  buffer_load_dwordx4 v3, s[12:15], s28 offen offset:1024 lds
  buffer_load_dwordx4 v4, s[12:15], s28 offen offset:2048 lds
  buffer_load_dwordx4 v5, s[12:15], s28 offen offset:3072 lds
  s_add_u32 m0, s30, 147456
  s_lshl_b32 s29, s32, 7
  buffer_load_dwordx4 v6, s[8:11], s29 offen offset:0 lds
  buffer_load_dwordx4 v7, s[8:11], s29 offen offset:1024 lds
  buffer_load_dwordx4 v8, s[8:11], s29 offen offset:2048 lds
  buffer_load_dwordx4 v9, s[8:11], s29 offen offset:3072 lds
  s_add_u32 s32, s32, 1
  s_cmp_eq_u32 s32, 10
  s_cselect_b32 s32, 0, s32
  s_waitcnt vmcnt(16)
  s_barrier
  s_add_u32 m0, s30, 0
  s_mul_i32 s28, s32, 245760
  buffer_load_dwordx4 v2, s[12:15], s28 offen offset:0 lds
  buffer_load_dwordx4 v3, s[12:15], s28 offen offset:1024 lds
  buffer_load_dwordx4 v4, s[12:15], s28 offen offset:2048 lds
  buffer_load_dwordx4 v5, s[12:15], s28 offen offset:3072 lds
  s_add_u32 m0, s30, 16384
  s_lshl_b32 s29, s32, 7
  buffer_load_dwordx4 v6, s[8:11], s29 offen offset:0 lds
  buffer_load_dwordx4 v7, s[8:11], s29 offen offset:1024 lds
  buffer_load_dwordx4 v8, s[8:11], s29 offen offset:2048 lds
  buffer_load_dwordx4 v9, s[8:11], s29 offen offset:3072 lds
  s_add_u32 s32, s32, 1
  s_cmp_eq_u32 s32, 10
  s_cselect_b32 s32, 0, s32
  s_waitcnt vmcnt(16)
  s_barrier
  s_add_u32 m0, s30, 32768
  s_mul_i32 s28, s32, 245760
  buffer_load_dwordx4 v2, s[12:15], s28 offen offset:0 lds
  buffer_load_dwordx4 v3, s[12:15], s28 offen offset:1024 lds
  buffer_load_dwordx4 v4, s[12:15], s28 offen offset:2048 lds
  buffer_load_dwordx4 v5, s[12:15], s28 offen offset:3072 lds
  s_add_u32 m0, s30, 49152
  s_lshl_b32 s29, s32, 7
  buffer_load_dwordx4 v6, s[8:11], s29 offen offset:0 lds
  buffer_load_dwordx4 v7, s[8:11], s29 offen offset:1024 lds
  buffer_load_dwordx4 v8, s[8:11], s29 offen offset:2048 lds
  buffer_load_dwordx4 v9, s[8:11], s29 offen offset:3072 lds
  s_add_u32 s32, s32, 1
  s_cmp_eq_u32 s32, 10
  s_cselect_b32 s32, 0, s32
  s_waitcnt vmcnt(16)
  s_barrier
  s_add_u32 m0, s30, 65536
  s_mul_i32 s28, s32, 245760
  buffer_load_dwordx4 v2, s[12:15], s28 offen offset:0 lds
  buffer_load_dwordx4 v3, s[12:15], s28 offen offset:1024 lds
  buffer_load_dwordx4 v4, s[12:15], s28 offen offset:2048 lds
  buffer_load_dwordx4 v5, s[12:15], s28 offen offset:3072 lds
  s_add_u32 m0, s30, 81920
  s_lshl_b32 s29, s32, 7
  buffer_load_dwordx4 v6, s[8:11], s29 offen offset:0 lds
  buffer_load_dwordx4 v7, s[8:11], s29 offen offset:1024 lds
  buffer_load_dwordx4 v8, s[8:11], s29 offen offset:2048 lds
  buffer_load_dwordx4 v9, s[8:11], s29 offen offset:3072 lds
  s_add_u32 s32, s32, 1
  s_cmp_eq_u32 s32, 10
  s_cselect_b32 s32, 0, s32
  s_waitcnt vmcnt(16)
  s_barrier
  s_add_u32 m0, s30, 98304
  s_mul_i32 s28, s32, 245760
  buffer_load_dwordx4 v2, s[12:15], s28 offen offset:0 lds
  buffer_load_dwordx4 v3, s[12:15], s28 offen offset:1024 lds
  buffer_load_dwordx4 v4, s[12:15], s28 offen offset:2048 lds
  buffer_load_dwordx4 v5, s[12:15], s28 offen offset:3072 lds
  s_add_u32 m0, s30, 114688
  s_lshl_b32 s29, s32, 7
  buffer_load_dwordx4 v6, s[8:11], s29 offen offset:0 lds
  buffer_load_dwordx4 v7, s[8:11], s29 offen offset:1024 lds
  buffer_load_dwordx4 v8, s[8:11], s29 offen offset:2048 lds
  buffer_load_dwordx4 v9, s[8:11], s29 offen offset:3072 lds
  s_add_u32 s32, s32, 1
  s_cmp_eq_u32 s32, 10
  s_cselect_b32 s32, 0, s32
  s_waitcnt vmcnt(16)
  s_barrier
  s_add_u32 m0, s30, 131072
  s_mul_i32 s28, s32, 245760
  buffer_load_dwordx4 v2, s[12:15], s28 offen offset:0 lds
  buffer_load_dwordx4 v3, s[12:15], s28 offen offset:1024 lds
  buffer_load_dwordx4 v4, s[12:15], s28 offen offset:2048 lds
  buffer_load_dwordx4 v5, s[12:15], s28 offen offset:3072 lds
  s_add_u32 m0, s30, 147456
  s_lshl_b32 s29, s32, 7
  buffer_load_dwordx4 v6, s[8:11], s29 offen offset:0 lds
  buffer_load_dwordx4 v7, s[8:11], s29 offen offset:1024 lds
  buffer_load_dwordx4 v8, s[8:11], s29 offen offset:2048 lds
  buffer_load_dwordx4 v9, s[8:11], s29 offen offset:3072 lds
  s_add_u32 s32, s32, 1
  s_cmp_eq_u32 s32, 10
  s_cselect_b32 s32, 0, s32
  s_waitcnt vmcnt(16)
  s_barrier
  buffer_load_dword v26, v24, s[44:47], 0 offen sc1
  v_mov_b32 v27, 64
  buffer_load_dword v27, v27, s[44:47], 0 offen sc1
  s_waitcnt vmcnt(10)
  s_barrier
  s_waitcnt vmcnt(2)
  s_barrier
  s_waitcnt vmcnt(0)
  v_readfirstlane_b32 s101, v27
  s_mov_b32 s60, 0
La_poll:
  v_readfirstlane_b32 s35, v26
  s_nop 3
  s_cmp_lg_u32 s35, 0
  s_cbranch_scc1 La_polled
  s_add_u32 s60, s60, 1
  s_cmp_ge_u32 s60, 200000
  s_cbranch_scc1 La_polled
  s_sleep 1
  buffer_load_dword v26, v24, s[44:47], 0 offen sc1
  s_waitcnt vmcnt(0)
  s_branch La_poll
La_polled:
  buffer_load_dwordx4 v[28:31], v25, s[16:19], s34 offen sc1
  v_lshlrev_b32 v26, 3, v1
  v_add_u32 v26, 96768, v26
  s_mov_b32 s36, 1.0
  s_cmp_lt_u32 s26, 5
  s_cselect_b32 s36, 0x3ea52b5c, s36
  s_barrier
  s_waitcnt vmcnt(0)
  v_mul_f32 v29, s36, v29
  v_mul_f32 v31, s36, v31
  v_mov_b32 v32, v28
  v_mov_b32 v33, v30
  v_mov_b32 v34, v29
  v_mov_b32 v35, v31
  ds_write_b64 v26, v[32:33] offset:0
  ds_write_b64 v26, v[34:35] offset:512
  s_waitcnt lgkmcnt(0)
  s_barrier
  s_cmp_lg_u32 s101, 0
  s_cbranch_scc1 Lnonce_1_ok
  v_mov_b32 v24, 64
  s_mov_b32 s33, 0
Lnonce_1:
  buffer_load_dword v25, v24, s[44:47], 0 offen sc1
  s_waitcnt vmcnt(0)
  v_readfirstlane_b32 s101, v25
  s_add_u32 s33, s33, 1
  s_nop 2
  s_cmp_lg_u32 s101, 0
  s_cbranch_scc1 Lnonce_1_ok
  s_sleep 4
  s_cmp_lt_u32 s33, 200000
  s_cbranch_scc1 Lnonce_1
Lnonce_1_ok:
  v_mov_b32 v24, 155432
  v_mov_b32 v25, s101
  ds_write_b32 v24, v25
  s_branch La_store
La_ltail:
  s_barrier
  s_barrier
  v_mov_b32 v24, 155392
  v_mov_b32 v26, 0
  v_mov_b32 v27, 0
  ds_write_b64 v24, v[26:27] offset:0
  ds_write_b64 v24, v[26:27] offset:8
  ds_write_b64 v24, v[26:27] offset:16
  ds_write_b64 v24, v[26:27] offset:24
  ds_write_b64 v24, v[26:27] offset:32
  s_branch La_store
La_ln:
  v_lshrrev_b32 v24, 4, v1
  s_lshl_b32 s33, s22, 2
  s_lshl_b32 s34, s25, 7
  s_add_u32 s33, s33, s34
  v_add_u32 v24, s33, v24
  v_and_b32 v25, 15, v1
  v_mul_u32_u24 v26, 1280, v24
  v_lshl_add_u32 v26, v25, 4, v26
  v_mov_b32 v27, 0x3f803f80
  s_waitcnt lgkmcnt(0)
  s_mov_b32 s8, s4
  s_and_b32 s9, s5, 0xffff
  s_mov_b32 s10, 2621440
  s_mov_b32 s11, 0x20000
  s_mov_b32 s16, s20
  s_and_b32 s17, s21, 0xffff
  s_mov_b32 s18, 16269312
  s_mov_b32 s19, 0x20000
  s_mov_b32 s44, s42
  s_and_b32 s45, s43, 0xffff
  s_mov_b32 s46, 256
  s_mov_b32 s47, 0x20000
  s_mov_b32 s35, 0
  buffer_load_dwordx4 v[32:35], v26, s[8:11], s35 offen offset:0
  buffer_load_dwordx4 v[36:39], v26, s[8:11], s35 offen offset:256
  buffer_load_dwordx4 v[40:43], v26, s[8:11], s35 offen offset:512
  buffer_load_dwordx4 v[44:47], v26, s[8:11], s35 offen offset:768
  buffer_load_dwordx4 v[48:51], v26, s[8:11], s35 offen offset:1024
  s_mov_b32 s35, 40960
  buffer_load_dwordx4 v[52:55], v26, s[8:11], s35 offen offset:0
  buffer_load_dwordx4 v[56:59], v26, s[8:11], s35 offen offset:256
  buffer_load_dwordx4 v[60:63], v26, s[8:11], s35 offen offset:512
  buffer_load_dwordx4 v[64:67], v26, s[8:11], s35 offen offset:768
  buffer_load_dwordx4 v[68:71], v26, s[8:11], s35 offen offset:1024
  s_mov_b32 s35, 81920
  buffer_load_dwordx4 v[72:75], v26, s[8:11], s35 offen offset:0
  buffer_load_dwordx4 v[76:79], v26, s[8:11], s35 offen offset:256
  buffer_load_dwordx4 v[80:83], v26, s[8:11], s35 offen offset:512
  buffer_load_dwordx4 v[84:87], v26, s[8:11], s35 offen offset:768
  buffer_load_dwordx4 v[88:91], v26, s[8:11], s35 offen offset:1024
  s_mov_b32 s35, 122880
  buffer_load_dwordx4 v[92:95], v26, s[8:11], s35 offen offset:0
  buffer_load_dwordx4 v[96:99], v26, s[8:11], s35 offen offset:256
  buffer_load_dwordx4 v[100:103], v26, s[8:11], s35 offen offset:512
  buffer_load_dwordx4 v[104:107], v26, s[8:11], s35 offen offset:768
  buffer_load_dwordx4 v[108:111], v26, s[8:11], s35 offen offset:1024
  v_mov_b32 v112, 0
  v_mov_b32 v113, 0
  v_mov_b32 v114, 0
  v_mov_b32 v115, 0
  v_mov_b32 v116, 0
  v_mov_b32 v117, 0
  v_mov_b32 v118, 0
  v_mov_b32 v119, 0
  v_lshlrev_b32 v28, 3, v24
  v_cmp_eq_u32 s[38:39], 0, v25
  v_mov_b32 v120, 155392
  v_mov_b32 v122, 0
  v_mov_b32 v123, 0
  ds_write_b64 v120, v[122:123] offset:0
  ds_write_b64 v120, v[122:123] offset:8
  ds_write_b64 v120, v[122:123] offset:16
  ds_write_b64 v120, v[122:123] offset:24
  ds_write_b64 v120, v[122:123] offset:32
  s_lshl_b32 s3, s25, 4
  s_add_u32 s3, s3, 65551
  v_mov_b32 v216, 0
  v_lshrrev_b32 v29, 4, v1
  s_lshl_b32 s37, s22, 2
  v_add_lshl_u32 v29, v29, s37, 3
  s_cmp_eq_u32 s22, 0
  s_cbranch_scc1 La_ln_w0
  s_waitcnt vmcnt(15)
  v_dot2c_f32_bf16 v112, v27, v32
  v_dot2c_f32_bf16 v113, v32, v32
  v_dot2c_f32_bf16 v112, v27, v33
  v_dot2c_f32_bf16 v113, v33, v33
  v_dot2c_f32_bf16 v112, v27, v34
  v_dot2c_f32_bf16 v113, v34, v34
  v_dot2c_f32_bf16 v112, v27, v35
  v_dot2c_f32_bf16 v113, v35, v35
  v_dot2c_f32_bf16 v112, v27, v36
  v_dot2c_f32_bf16 v113, v36, v36
  v_dot2c_f32_bf16 v112, v27, v37
  v_dot2c_f32_bf16 v113, v37, v37
  v_dot2c_f32_bf16 v112, v27, v38
  v_dot2c_f32_bf16 v113, v38, v38
  v_dot2c_f32_bf16 v112, v27, v39
  v_dot2c_f32_bf16 v113, v39, v39
  v_dot2c_f32_bf16 v112, v27, v40
  v_dot2c_f32_bf16 v113, v40, v40
  v_dot2c_f32_bf16 v112, v27, v41
  v_dot2c_f32_bf16 v113, v41, v41
  v_dot2c_f32_bf16 v112, v27, v42
  v_dot2c_f32_bf16 v113, v42, v42
  v_dot2c_f32_bf16 v112, v27, v43
  v_dot2c_f32_bf16 v113, v43, v43
  v_dot2c_f32_bf16 v112, v27, v44
  v_dot2c_f32_bf16 v113, v44, v44
  v_dot2c_f32_bf16 v112, v27, v45
  v_dot2c_f32_bf16 v113, v45, v45
  v_dot2c_f32_bf16 v112, v27, v46
  v_dot2c_f32_bf16 v113, v46, v46
  v_dot2c_f32_bf16 v112, v27, v47
  v_dot2c_f32_bf16 v113, v47, v47
  v_dot2c_f32_bf16 v112, v27, v48
  v_dot2c_f32_bf16 v113, v48, v48
  v_dot2c_f32_bf16 v112, v27, v49
  v_dot2c_f32_bf16 v113, v49, v49
  v_dot2c_f32_bf16 v112, v27, v50
  v_dot2c_f32_bf16 v113, v50, v50
  v_dot2c_f32_bf16 v112, v27, v51
  v_dot2c_f32_bf16 v113, v51, v51
  s_nop 2
  v_add_f32_dpp v112, v112, v112 row_ror:8 row_mask:0xf bank_mask:0xf
  v_add_f32_dpp v113, v113, v113 row_ror:8 row_mask:0xf bank_mask:0xf
  s_nop 0
  v_add_f32_dpp v112, v112, v112 row_ror:4 row_mask:0xf bank_mask:0xf
  v_add_f32_dpp v113, v113, v113 row_ror:4 row_mask:0xf bank_mask:0xf
  s_nop 0
  v_add_f32_dpp v112, v112, v112 row_ror:2 row_mask:0xf bank_mask:0xf
  v_add_f32_dpp v113, v113, v113 row_ror:2 row_mask:0xf bank_mask:0xf
  s_nop 0
  v_add_f32_dpp v112, v112, v112 row_ror:1 row_mask:0xf bank_mask:0xf
  v_add_f32_dpp v113, v113, v113 row_ror:1 row_mask:0xf bank_mask:0xf
  s_nop 0
  v_mul_f32 v120, 0x3acccccd, v112
  v_mul_f32 v30, 0x3acccccd, v113
  v_fma_f32 v30, -v120, v120, v30
  v_max_f32 v30, 0, v30
  v_add_f32 v31, 0x3727c5ac, v30
  v_rsq_f32 v121, v31
  s_nop 0
  v_mul_f32 v31, v121, v121
  v_mul_f32 v31, v31, v30
  v_add_f32 v31, 0x3727c5ac, v31
  v_rsq_f32 v31, v31
  s_nop 0
  v_mul_f32 v128, v31, v121
  v_mul_f32 v129, v128, v120
  s_mov_b64 exec, s[38:39]
  ds_write_b64 v29, v[120:121] offset:0
  s_mov_b64 exec, -1
  s_waitcnt vmcnt(10)
  v_dot2c_f32_bf16 v114, v27, v52
  v_dot2c_f32_bf16 v115, v52, v52
  v_dot2c_f32_bf16 v114, v27, v53
  v_dot2c_f32_bf16 v115, v53, v53
  v_dot2c_f32_bf16 v114, v27, v54
  v_dot2c_f32_bf16 v115, v54, v54
  v_dot2c_f32_bf16 v114, v27, v55
  v_dot2c_f32_bf16 v115, v55, v55
  v_dot2c_f32_bf16 v114, v27, v56
  v_dot2c_f32_bf16 v115, v56, v56
  v_dot2c_f32_bf16 v114, v27, v57
  v_dot2c_f32_bf16 v115, v57, v57
  v_dot2c_f32_bf16 v114, v27, v58
  v_dot2c_f32_bf16 v115, v58, v58
  v_dot2c_f32_bf16 v114, v27, v59
  v_dot2c_f32_bf16 v115, v59, v59
  v_dot2c_f32_bf16 v114, v27, v60
  v_dot2c_f32_bf16 v115, v60, v60
  v_dot2c_f32_bf16 v114, v27, v61
  v_dot2c_f32_bf16 v115, v61, v61
  v_dot2c_f32_bf16 v114, v27, v62
  v_dot2c_f32_bf16 v115, v62, v62
  v_dot2c_f32_bf16 v114, v27, v63
  v_dot2c_f32_bf16 v115, v63, v63
  v_dot2c_f32_bf16 v114, v27, v64
  v_dot2c_f32_bf16 v115, v64, v64
  v_dot2c_f32_bf16 v114, v27, v65
  v_dot2c_f32_bf16 v115, v65, v65
  v_dot2c_f32_bf16 v114, v27, v66
  v_dot2c_f32_bf16 v115, v66, v66
  v_dot2c_f32_bf16 v114, v27, v67
  v_dot2c_f32_bf16 v115, v67, v67
  v_dot2c_f32_bf16 v114, v27, v68
  v_dot2c_f32_bf16 v115, v68, v68
  v_dot2c_f32_bf16 v114, v27, v69
  v_dot2c_f32_bf16 v115, v69, v69
  v_dot2c_f32_bf16 v114, v27, v70
  v_dot2c_f32_bf16 v115, v70, v70
  v_dot2c_f32_bf16 v114, v27, v71
  v_dot2c_f32_bf16 v115, v71, v71
  s_nop 2
  v_add_f32_dpp v114, v114, v114 row_ror:8 row_mask:0xf bank_mask:0xf
  v_add_f32_dpp v115, v115, v115 row_ror:8 row_mask:0xf bank_mask:0xf
  s_nop 0
  v_add_f32_dpp v114, v114, v114 row_ror:4 row_mask:0xf bank_mask:0xf
  v_add_f32_dpp v115, v115, v115 row_ror:4 row_mask:0xf bank_mask:0xf
  s_nop 0
  v_add_f32_dpp v114, v114, v114 row_ror:2 row_mask:0xf bank_mask:0xf
  v_add_f32_dpp v115, v115, v115 row_ror:2 row_mask:0xf bank_mask:0xf
  s_nop 0
  v_add_f32_dpp v114, v114, v114 row_ror:1 row_mask:0xf bank_mask:0xf
  v_add_f32_dpp v115, v115, v115 row_ror:1 row_mask:0xf bank_mask:0xf
  s_nop 0
  v_mul_f32 v122, 0x3acccccd, v114
  v_mul_f32 v30, 0x3acccccd, v115
  v_fma_f32 v30, -v122, v122, v30
  v_max_f32 v30, 0, v30
  v_add_f32 v31, 0x3727c5ac, v30
  v_rsq_f32 v123, v31
  s_nop 0
  v_mul_f32 v31, v123, v123
  v_mul_f32 v31, v31, v30
  v_add_f32 v31, 0x3727c5ac, v31
  v_rsq_f32 v31, v31
  s_nop 0
  v_mul_f32 v130, v31, v123
  v_mul_f32 v131, v130, v122
  s_mov_b64 exec, s[38:39]
  ds_write_b64 v29, v[122:123] offset:256
  s_mov_b64 exec, -1
  s_waitcnt vmcnt(5)
  v_dot2c_f32_bf16 v116, v27, v72
  v_dot2c_f32_bf16 v117, v72, v72
  v_dot2c_f32_bf16 v116, v27, v73
  v_dot2c_f32_bf16 v117, v73, v73
  v_dot2c_f32_bf16 v116, v27, v74
  v_dot2c_f32_bf16 v117, v74, v74
  v_dot2c_f32_bf16 v116, v27, v75
  v_dot2c_f32_bf16 v117, v75, v75
  v_dot2c_f32_bf16 v116, v27, v76
  v_dot2c_f32_bf16 v117, v76, v76
  v_dot2c_f32_bf16 v116, v27, v77
  v_dot2c_f32_bf16 v117, v77, v77
  v_dot2c_f32_bf16 v116, v27, v78
  v_dot2c_f32_bf16 v117, v78, v78
  v_dot2c_f32_bf16 v116, v27, v79
  v_dot2c_f32_bf16 v117, v79, v79
  v_dot2c_f32_bf16 v116, v27, v80
  v_dot2c_f32_bf16 v117, v80, v80
  v_dot2c_f32_bf16 v116, v27, v81
  v_dot2c_f32_bf16 v117, v81, v81
  v_dot2c_f32_bf16 v116, v27, v82
  v_dot2c_f32_bf16 v117, v82, v82
  v_dot2c_f32_bf16 v116, v27, v83
  v_dot2c_f32_bf16 v117, v83, v83
  v_dot2c_f32_bf16 v116, v27, v84
  v_dot2c_f32_bf16 v117, v84, v84
  v_dot2c_f32_bf16 v116, v27, v85
  v_dot2c_f32_bf16 v117, v85, v85
  v_dot2c_f32_bf16 v116, v27, v86
  v_dot2c_f32_bf16 v117, v86, v86
  v_dot2c_f32_bf16 v116, v27, v87
  v_dot2c_f32_bf16 v117, v87, v87
  v_dot2c_f32_bf16 v116, v27, v88
  v_dot2c_f32_bf16 v117, v88, v88
  v_dot2c_f32_bf16 v116, v27, v89
  v_dot2c_f32_bf16 v117, v89, v89
  v_dot2c_f32_bf16 v116, v27, v90
  v_dot2c_f32_bf16 v117, v90, v90
  v_dot2c_f32_bf16 v116, v27, v91
  v_dot2c_f32_bf16 v117, v91, v91
  s_nop 2
  v_add_f32_dpp v116, v116, v116 row_ror:8 row_mask:0xf bank_mask:0xf
  v_add_f32_dpp v117, v117, v117 row_ror:8 row_mask:0xf bank_mask:0xf
  s_nop 0
  v_add_f32_dpp v116, v116, v116 row_ror:4 row_mask:0xf bank_mask:0xf
  v_add_f32_dpp v117, v117, v117 row_ror:4 row_mask:0xf bank_mask:0xf
  s_nop 0
  v_add_f32_dpp v116, v116, v116 row_ror:2 row_mask:0xf bank_mask:0xf
  v_add_f32_dpp v117, v117, v117 row_ror:2 row_mask:0xf bank_mask:0xf
  s_nop 0
  v_add_f32_dpp v116, v116, v116 row_ror:1 row_mask:0xf bank_mask:0xf
  v_add_f32_dpp v117, v117, v117 row_ror:1 row_mask:0xf bank_mask:0xf
  s_nop 0
  v_mul_f32 v124, 0x3acccccd, v116
  v_mul_f32 v30, 0x3acccccd, v117
  v_fma_f32 v30, -v124, v124, v30
  v_max_f32 v30, 0, v30
  v_add_f32 v31, 0x3727c5ac, v30
  v_rsq_f32 v125, v31
  s_nop 0
  v_mul_f32 v31, v125, v125
  v_mul_f32 v31, v31, v30
  v_add_f32 v31, 0x3727c5ac, v31
  v_rsq_f32 v31, v31
  s_nop 0
  v_mul_f32 v132, v31, v125
  v_mul_f32 v133, v132, v124
  s_mov_b64 exec, s[38:39]
  ds_write_b64 v29, v[124:125] offset:512
  s_mov_b64 exec, -1
  s_waitcnt vmcnt(0)
  v_dot2c_f32_bf16 v118, v27, v92
  v_dot2c_f32_bf16 v119, v92, v92
  v_dot2c_f32_bf16 v118, v27, v93
  v_dot2c_f32_bf16 v119, v93, v93
  v_dot2c_f32_bf16 v118, v27, v94
  v_dot2c_f32_bf16 v119, v94, v94
  v_dot2c_f32_bf16 v118, v27, v95
  v_dot2c_f32_bf16 v119, v95, v95
  v_dot2c_f32_bf16 v118, v27, v96
  v_dot2c_f32_bf16 v119, v96, v96
  v_dot2c_f32_bf16 v118, v27, v97
  v_dot2c_f32_bf16 v119, v97, v97
  v_dot2c_f32_bf16 v118, v27, v98
  v_dot2c_f32_bf16 v119, v98, v98
  v_dot2c_f32_bf16 v118, v27, v99
  v_dot2c_f32_bf16 v119, v99, v99
  v_dot2c_f32_bf16 v118, v27, v100
  v_dot2c_f32_bf16 v119, v100, v100
  v_dot2c_f32_bf16 v118, v27, v101
  v_dot2c_f32_bf16 v119, v101, v101
  v_dot2c_f32_bf16 v118, v27, v102
  v_dot2c_f32_bf16 v119, v102, v102
  v_dot2c_f32_bf16 v118, v27, v103
  v_dot2c_f32_bf16 v119, v103, v103
  v_dot2c_f32_bf16 v118, v27, v104
  v_dot2c_f32_bf16 v119, v104, v104
  v_dot2c_f32_bf16 v118, v27, v105
  v_dot2c_f32_bf16 v119, v105, v105
  v_dot2c_f32_bf16 v118, v27, v106
  v_dot2c_f32_bf16 v119, v106, v106
  v_dot2c_f32_bf16 v118, v27, v107
  v_dot2c_f32_bf16 v119, v107, v107
  v_dot2c_f32_bf16 v118, v27, v108
  v_dot2c_f32_bf16 v119, v108, v108
  v_dot2c_f32_bf16 v118, v27, v109
  v_dot2c_f32_bf16 v119, v109, v109
  v_dot2c_f32_bf16 v118, v27, v110
  v_dot2c_f32_bf16 v119, v110, v110
  v_dot2c_f32_bf16 v118, v27, v111
  v_dot2c_f32_bf16 v119, v111, v111
  s_nop 2
  v_add_f32_dpp v118, v118, v118 row_ror:8 row_mask:0xf bank_mask:0xf
  v_add_f32_dpp v119, v119, v119 row_ror:8 row_mask:0xf bank_mask:0xf
  s_nop 0
  v_add_f32_dpp v118, v118, v118 row_ror:4 row_mask:0xf bank_mask:0xf
  v_add_f32_dpp v119, v119, v119 row_ror:4 row_mask:0xf bank_mask:0xf
  s_nop 0
  v_add_f32_dpp v118, v118, v118 row_ror:2 row_mask:0xf bank_mask:0xf
  v_add_f32_dpp v119, v119, v119 row_ror:2 row_mask:0xf bank_mask:0xf
  s_nop 0
  v_add_f32_dpp v118, v118, v118 row_ror:1 row_mask:0xf bank_mask:0xf
  v_add_f32_dpp v119, v119, v119 row_ror:1 row_mask:0xf bank_mask:0xf
  s_nop 0
  v_mul_f32 v126, 0x3acccccd, v118
  v_mul_f32 v30, 0x3acccccd, v119
  v_fma_f32 v30, -v126, v126, v30
  v_max_f32 v30, 0, v30
  v_add_f32 v31, 0x3727c5ac, v30
  v_rsq_f32 v127, v31
  s_nop 0
  v_mul_f32 v31, v127, v127
  v_mul_f32 v31, v31, v30
  v_add_f32 v31, 0x3727c5ac, v31
  v_rsq_f32 v31, v31
  s_nop 0
  v_mul_f32 v134, v31, v127
  v_mul_f32 v135, v134, v126
  s_mov_b64 exec, s[38:39]
  ds_write_b64 v29, v[126:127] offset:768
  s_mov_b64 exec, -1
  s_waitcnt lgkmcnt(0)
  s_barrier
  v_lshlrev_b32 v30, 16, v32
  v_and_b32 v31, 0xffff0000, v32
  v_pk_fma_f32 v[30:31], v[30:31], v[128:129], v[128:129] op_sel:[0,0,1] op_sel_hi:[1,0,1] neg_lo:[0,0,1] neg_hi:[0,0,1]
  v_cvt_pk_bf16_f32 v32, v30, v31
  v_lshlrev_b32 v30, 16, v33
  v_and_b32 v31, 0xffff0000, v33
  v_pk_fma_f32 v[30:31], v[30:31], v[128:129], v[128:129] op_sel:[0,0,1] op_sel_hi:[1,0,1] neg_lo:[0,0,1] neg_hi:[0,0,1]
  v_cvt_pk_bf16_f32 v33, v30, v31
  v_lshlrev_b32 v30, 16, v34
  v_and_b32 v31, 0xffff0000, v34
  v_pk_fma_f32 v[30:31], v[30:31], v[128:129], v[128:129] op_sel:[0,0,1] op_sel_hi:[1,0,1] neg_lo:[0,0,1] neg_hi:[0,0,1]
  v_cvt_pk_bf16_f32 v34, v30, v31
  v_lshlrev_b32 v30, 16, v35
  v_and_b32 v31, 0xffff0000, v35
  v_pk_fma_f32 v[30:31], v[30:31], v[128:129], v[128:129] op_sel:[0,0,1] op_sel_hi:[1,0,1] neg_lo:[0,0,1] neg_hi:[0,0,1]
  v_cvt_pk_bf16_f32 v35, v30, v31
  v_lshlrev_b32 v30, 16, v36
  v_and_b32 v31, 0xffff0000, v36
  v_pk_fma_f32 v[30:31], v[30:31], v[128:129], v[128:129] op_sel:[0,0,1] op_sel_hi:[1,0,1] neg_lo:[0,0,1] neg_hi:[0,0,1]
  v_cvt_pk_bf16_f32 v36, v30, v31
  v_lshlrev_b32 v30, 16, v37
  v_and_b32 v31, 0xffff0000, v37
  v_pk_fma_f32 v[30:31], v[30:31], v[128:129], v[128:129] op_sel:[0,0,1] op_sel_hi:[1,0,1] neg_lo:[0,0,1] neg_hi:[0,0,1]
  v_cvt_pk_bf16_f32 v37, v30, v31
  v_lshlrev_b32 v30, 16, v38
  v_and_b32 v31, 0xffff0000, v38
  v_pk_fma_f32 v[30:31], v[30:31], v[128:129], v[128:129] op_sel:[0,0,1] op_sel_hi:[1,0,1] neg_lo:[0,0,1] neg_hi:[0,0,1]
  v_cvt_pk_bf16_f32 v38, v30, v31
  v_lshlrev_b32 v30, 16, v39
  v_and_b32 v31, 0xffff0000, v39
  v_pk_fma_f32 v[30:31], v[30:31], v[128:129], v[128:129] op_sel:[0,0,1] op_sel_hi:[1,0,1] neg_lo:[0,0,1] neg_hi:[0,0,1]
  v_cvt_pk_bf16_f32 v39, v30, v31
  v_lshlrev_b32 v30, 16, v40
  v_and_b32 v31, 0xffff0000, v40
  v_pk_fma_f32 v[30:31], v[30:31], v[128:129], v[128:129] op_sel:[0,0,1] op_sel_hi:[1,0,1] neg_lo:[0,0,1] neg_hi:[0,0,1]
  v_cvt_pk_bf16_f32 v40, v30, v31
  v_lshlrev_b32 v30, 16, v41
  v_and_b32 v31, 0xffff0000, v41
  v_pk_fma_f32 v[30:31], v[30:31], v[128:129], v[128:129] op_sel:[0,0,1] op_sel_hi:[1,0,1] neg_lo:[0,0,1] neg_hi:[0,0,1]
  v_cvt_pk_bf16_f32 v41, v30, v31
  v_lshlrev_b32 v30, 16, v42
  v_and_b32 v31, 0xffff0000, v42
  v_pk_fma_f32 v[30:31], v[30:31], v[128:129], v[128:129] op_sel:[0,0,1] op_sel_hi:[1,0,1] neg_lo:[0,0,1] neg_hi:[0,0,1]
  v_cvt_pk_bf16_f32 v42, v30, v31
  v_lshlrev_b32 v30, 16, v43
  v_and_b32 v31, 0xffff0000, v43
  v_pk_fma_f32 v[30:31], v[30:31], v[128:129], v[128:129] op_sel:[0,0,1] op_sel_hi:[1,0,1] neg_lo:[0,0,1] neg_hi:[0,0,1]
  v_cvt_pk_bf16_f32 v43, v30, v31
  v_lshlrev_b32 v30, 16, v44
  v_and_b32 v31, 0xffff0000, v44
  v_pk_fma_f32 v[30:31], v[30:31], v[128:129], v[128:129] op_sel:[0,0,1] op_sel_hi:[1,0,1] neg_lo:[0,0,1] neg_hi:[0,0,1]
  v_cvt_pk_bf16_f32 v44, v30, v31
  v_lshlrev_b32 v30, 16, v45
  v_and_b32 v31, 0xffff0000, v45
  v_pk_fma_f32 v[30:31], v[30:31], v[128:129], v[128:129] op_sel:[0,0,1] op_sel_hi:[1,0,1] neg_lo:[0,0,1] neg_hi:[0,0,1]
  v_cvt_pk_bf16_f32 v45, v30, v31
  v_lshlrev_b32 v30, 16, v46
  v_and_b32 v31, 0xffff0000, v46
  v_pk_fma_f32 v[30:31], v[30:31], v[128:129], v[128:129] op_sel:[0,0,1] op_sel_hi:[1,0,1] neg_lo:[0,0,1] neg_hi:[0,0,1]
  v_cvt_pk_bf16_f32 v46, v30, v31
  v_lshlrev_b32 v30, 16, v47
  v_and_b32 v31, 0xffff0000, v47
  v_pk_fma_f32 v[30:31], v[30:31], v[128:129], v[128:129] op_sel:[0,0,1] op_sel_hi:[1,0,1] neg_lo:[0,0,1] neg_hi:[0,0,1]
  v_cvt_pk_bf16_f32 v47, v30, v31
  v_lshlrev_b32 v30, 16, v48
  v_and_b32 v31, 0xffff0000, v48
  v_pk_fma_f32 v[30:31], v[30:31], v[128:129], v[128:129] op_sel:[0,0,1] op_sel_hi:[1,0,1] neg_lo:[0,0,1] neg_hi:[0,0,1]
  v_cvt_pk_bf16_f32 v48, v30, v31
  v_lshlrev_b32 v30, 16, v49
  v_and_b32 v31, 0xffff0000, v49
  v_pk_fma_f32 v[30:31], v[30:31], v[128:129], v[128:129] op_sel:[0,0,1] op_sel_hi:[1,0,1] neg_lo:[0,0,1] neg_hi:[0,0,1]
  v_cvt_pk_bf16_f32 v49, v30, v31
  v_lshlrev_b32 v30, 16, v50
  v_and_b32 v31, 0xffff0000, v50
  v_pk_fma_f32 v[30:31], v[30:31], v[128:129], v[128:129] op_sel:[0,0,1] op_sel_hi:[1,0,1] neg_lo:[0,0,1] neg_hi:[0,0,1]
  v_cvt_pk_bf16_f32 v50, v30, v31
  v_lshlrev_b32 v30, 16, v51
  v_and_b32 v31, 0xffff0000, v51
  v_pk_fma_f32 v[30:31], v[30:31], v[128:129], v[128:129] op_sel:[0,0,1] op_sel_hi:[1,0,1] neg_lo:[0,0,1] neg_hi:[0,0,1]
  v_cvt_pk_bf16_f32 v51, v30, v31
  s_mov_b32 s35, 7864320
  buffer_store_dwordx4 v[32:35], v26, s[16:19], s35 offen offset:0 sc1
  buffer_store_dwordx4 v[36:39], v26, s[16:19], s35 offen offset:256 sc1
  buffer_store_dwordx4 v[40:43], v26, s[16:19], s35 offen offset:512 sc1
  buffer_store_dwordx4 v[44:47], v26, s[16:19], s35 offen offset:768 sc1
  buffer_store_dwordx4 v[48:51], v26, s[16:19], s35 offen offset:1024 sc1
  v_lshlrev_b32 v30, 16, v52
  v_and_b32 v31, 0xffff0000, v52
  v_pk_fma_f32 v[30:31], v[30:31], v[130:131], v[130:131] op_sel:[0,0,1] op_sel_hi:[1,0,1] neg_lo:[0,0,1] neg_hi:[0,0,1]
  v_cvt_pk_bf16_f32 v52, v30, v31
  v_lshlrev_b32 v30, 16, v53
  v_and_b32 v31, 0xffff0000, v53
  v_pk_fma_f32 v[30:31], v[30:31], v[130:131], v[130:131] op_sel:[0,0,1] op_sel_hi:[1,0,1] neg_lo:[0,0,1] neg_hi:[0,0,1]
  v_cvt_pk_bf16_f32 v53, v30, v31
  v_lshlrev_b32 v30, 16, v54
  v_and_b32 v31, 0xffff0000, v54
  v_pk_fma_f32 v[30:31], v[30:31], v[130:131], v[130:131] op_sel:[0,0,1] op_sel_hi:[1,0,1] neg_lo:[0,0,1] neg_hi:[0,0,1]
  v_cvt_pk_bf16_f32 v54, v30, v31
  v_lshlrev_b32 v30, 16, v55
  v_and_b32 v31, 0xffff0000, v55
  v_pk_fma_f32 v[30:31], v[30:31], v[130:131], v[130:131] op_sel:[0,0,1] op_sel_hi:[1,0,1] neg_lo:[0,0,1] neg_hi:[0,0,1]
  v_cvt_pk_bf16_f32 v55, v30, v31
  v_lshlrev_b32 v30, 16, v56
  v_and_b32 v31, 0xffff0000, v56
  v_pk_fma_f32 v[30:31], v[30:31], v[130:131], v[130:131] op_sel:[0,0,1] op_sel_hi:[1,0,1] neg_lo:[0,0,1] neg_hi:[0,0,1]
  v_cvt_pk_bf16_f32 v56, v30, v31
  v_lshlrev_b32 v30, 16, v57
  v_and_b32 v31, 0xffff0000, v57
  v_pk_fma_f32 v[30:31], v[30:31], v[130:131], v[130:131] op_sel:[0,0,1] op_sel_hi:[1,0,1] neg_lo:[0,0,1] neg_hi:[0,0,1]
  v_cvt_pk_bf16_f32 v57, v30, v31
  v_lshlrev_b32 v30, 16, v58
  v_and_b32 v31, 0xffff0000, v58
  v_pk_fma_f32 v[30:31], v[30:31], v[130:131], v[130:131] op_sel:[0,0,1] op_sel_hi:[1,0,1] neg_lo:[0,0,1] neg_hi:[0,0,1]
  v_cvt_pk_bf16_f32 v58, v30, v31
  v_lshlrev_b32 v30, 16, v59
  v_and_b32 v31, 0xffff0000, v59
  v_pk_fma_f32 v[30:31], v[30:31], v[130:131], v[130:131] op_sel:[0,0,1] op_sel_hi:[1,0,1] neg_lo:[0,0,1] neg_hi:[0,0,1]
  v_cvt_pk_bf16_f32 v59, v30, v31
  v_lshlrev_b32 v30, 16, v60
  v_and_b32 v31, 0xffff0000, v60
  v_pk_fma_f32 v[30:31], v[30:31], v[130:131], v[130:131] op_sel:[0,0,1] op_sel_hi:[1,0,1] neg_lo:[0,0,1] neg_hi:[0,0,1]
  v_cvt_pk_bf16_f32 v60, v30, v31
  v_lshlrev_b32 v30, 16, v61
  v_and_b32 v31, 0xffff0000, v61
  v_pk_fma_f32 v[30:31], v[30:31], v[130:131], v[130:131] op_sel:[0,0,1] op_sel_hi:[1,0,1] neg_lo:[0,0,1] neg_hi:[0,0,1]
  v_cvt_pk_bf16_f32 v61, v30, v31
  v_lshlrev_b32 v30, 16, v62
  v_and_b32 v31, 0xffff0000, v62
  v_pk_fma_f32 v[30:31], v[30:31], v[130:131], v[130:131] op_sel:[0,0,1] op_sel_hi:[1,0,1] neg_lo:[0,0,1] neg_hi:[0,0,1]
  v_cvt_pk_bf16_f32 v62, v30, v31
  v_lshlrev_b32 v30, 16, v63
  v_and_b32 v31, 0xffff0000, v63
  v_pk_fma_f32 v[30:31], v[30:31], v[130:131], v[130:131] op_sel:[0,0,1] op_sel_hi:[1,0,1] neg_lo:[0,0,1] neg_hi:[0,0,1]
  v_cvt_pk_bf16_f32 v63, v30, v31
  v_lshlrev_b32 v30, 16, v64
  v_and_b32 v31, 0xffff0000, v64
  v_pk_fma_f32 v[30:31], v[30:31], v[130:131], v[130:131] op_sel:[0,0,1] op_sel_hi:[1,0,1] neg_lo:[0,0,1] neg_hi:[0,0,1]
  v_cvt_pk_bf16_f32 v64, v30, v31
  v_lshlrev_b32 v30, 16, v65
  v_and_b32 v31, 0xffff0000, v65
  v_pk_fma_f32 v[30:31], v[30:31], v[130:131], v[130:131] op_sel:[0,0,1] op_sel_hi:[1,0,1] neg_lo:[0,0,1] neg_hi:[0,0,1]
  v_cvt_pk_bf16_f32 v65, v30, v31
  v_lshlrev_b32 v30, 16, v66
  v_and_b32 v31, 0xffff0000, v66
  v_pk_fma_f32 v[30:31], v[30:31], v[130:131], v[130:131] op_sel:[0,0,1] op_sel_hi:[1,0,1] neg_lo:[0,0,1] neg_hi:[0,0,1]
  v_cvt_pk_bf16_f32 v66, v30, v31
  v_lshlrev_b32 v30, 16, v67
  v_and_b32 v31, 0xffff0000, v67
  v_pk_fma_f32 v[30:31], v[30:31], v[130:131], v[130:131] op_sel:[0,0,1] op_sel_hi:[1,0,1] neg_lo:[0,0,1] neg_hi:[0,0,1]
  v_cvt_pk_bf16_f32 v67, v30, v31
  v_lshlrev_b32 v30, 16, v68
  v_and_b32 v31, 0xffff0000, v68
  v_pk_fma_f32 v[30:31], v[30:31], v[130:131], v[130:131] op_sel:[0,0,1] op_sel_hi:[1,0,1] neg_lo:[0,0,1] neg_hi:[0,0,1]
  v_cvt_pk_bf16_f32 v68, v30, v31
  v_lshlrev_b32 v30, 16, v69
  v_and_b32 v31, 0xffff0000, v69
  v_pk_fma_f32 v[30:31], v[30:31], v[130:131], v[130:131] op_sel:[0,0,1] op_sel_hi:[1,0,1] neg_lo:[0,0,1] neg_hi:[0,0,1]
  v_cvt_pk_bf16_f32 v69, v30, v31
  v_lshlrev_b32 v30, 16, v70
  v_and_b32 v31, 0xffff0000, v70
  v_pk_fma_f32 v[30:31], v[30:31], v[130:131], v[130:131] op_sel:[0,0,1] op_sel_hi:[1,0,1] neg_lo:[0,0,1] neg_hi:[0,0,1]
  v_cvt_pk_bf16_f32 v70, v30, v31
  v_lshlrev_b32 v30, 16, v71
  v_and_b32 v31, 0xffff0000, v71
  v_pk_fma_f32 v[30:31], v[30:31], v[130:131], v[130:131] op_sel:[0,0,1] op_sel_hi:[1,0,1] neg_lo:[0,0,1] neg_hi:[0,0,1]
  v_cvt_pk_bf16_f32 v71, v30, v31
  s_mov_b32 s35, 7905280
  buffer_store_dwordx4 v[52:55], v26, s[16:19], s35 offen offset:0 sc1
  buffer_store_dwordx4 v[56:59], v26, s[16:19], s35 offen offset:256 sc1
  buffer_store_dwordx4 v[60:63], v26, s[16:19], s35 offen offset:512 sc1
  buffer_store_dwordx4 v[64:67], v26, s[16:19], s35 offen offset:768 sc1
  buffer_store_dwordx4 v[68:71], v26, s[16:19], s35 offen offset:1024 sc1
  v_lshlrev_b32 v30, 16, v72
  v_and_b32 v31, 0xffff0000, v72
  v_pk_fma_f32 v[30:31], v[30:31], v[132:133], v[132:133] op_sel:[0,0,1] op_sel_hi:[1,0,1] neg_lo:[0,0,1] neg_hi:[0,0,1]
  v_cvt_pk_bf16_f32 v72, v30, v31
  v_lshlrev_b32 v30, 16, v73
  v_and_b32 v31, 0xffff0000, v73
  v_pk_fma_f32 v[30:31], v[30:31], v[132:133], v[132:133] op_sel:[0,0,1] op_sel_hi:[1,0,1] neg_lo:[0,0,1] neg_hi:[0,0,1]
  v_cvt_pk_bf16_f32 v73, v30, v31
  v_lshlrev_b32 v30, 16, v74
  v_and_b32 v31, 0xffff0000, v74
  v_pk_fma_f32 v[30:31], v[30:31], v[132:133], v[132:133] op_sel:[0,0,1] op_sel_hi:[1,0,1] neg_lo:[0,0,1] neg_hi:[0,0,1]
  v_cvt_pk_bf16_f32 v74, v30, v31
  v_lshlrev_b32 v30, 16, v75
  v_and_b32 v31, 0xffff0000, v75
  v_pk_fma_f32 v[30:31], v[30:31], v[132:133], v[132:133] op_sel:[0,0,1] op_sel_hi:[1,0,1] neg_lo:[0,0,1] neg_hi:[0,0,1]
  v_cvt_pk_bf16_f32 v75, v30, v31
  v_lshlrev_b32 v30, 16, v76
  v_and_b32 v31, 0xffff0000, v76
  v_pk_fma_f32 v[30:31], v[30:31], v[132:133], v[132:133] op_sel:[0,0,1] op_sel_hi:[1,0,1] neg_lo:[0,0,1] neg_hi:[0,0,1]
  v_cvt_pk_bf16_f32 v76, v30, v31
  v_lshlrev_b32 v30, 16, v77
  v_and_b32 v31, 0xffff0000, v77
  v_pk_fma_f32 v[30:31], v[30:31], v[132:133], v[132:133] op_sel:[0,0,1] op_sel_hi:[1,0,1] neg_lo:[0,0,1] neg_hi:[0,0,1]
  v_cvt_pk_bf16_f32 v77, v30, v31
  v_lshlrev_b32 v30, 16, v78
  v_and_b32 v31, 0xffff0000, v78
  v_pk_fma_f32 v[30:31], v[30:31], v[132:133], v[132:133] op_sel:[0,0,1] op_sel_hi:[1,0,1] neg_lo:[0,0,1] neg_hi:[0,0,1]
  v_cvt_pk_bf16_f32 v78, v30, v31
  v_lshlrev_b32 v30, 16, v79
  v_and_b32 v31, 0xffff0000, v79
  v_pk_fma_f32 v[30:31], v[30:31], v[132:133], v[132:133] op_sel:[0,0,1] op_sel_hi:[1,0,1] neg_lo:[0,0,1] neg_hi:[0,0,1]
  v_cvt_pk_bf16_f32 v79, v30, v31
  v_lshlrev_b32 v30, 16, v80
  v_and_b32 v31, 0xffff0000, v80
  v_pk_fma_f32 v[30:31], v[30:31], v[132:133], v[132:133] op_sel:[0,0,1] op_sel_hi:[1,0,1] neg_lo:[0,0,1] neg_hi:[0,0,1]
  v_cvt_pk_bf16_f32 v80, v30, v31
  v_lshlrev_b32 v30, 16, v81
  v_and_b32 v31, 0xffff0000, v81
  v_pk_fma_f32 v[30:31], v[30:31], v[132:133], v[132:133] op_sel:[0,0,1] op_sel_hi:[1,0,1] neg_lo:[0,0,1] neg_hi:[0,0,1]
  v_cvt_pk_bf16_f32 v81, v30, v31
  v_lshlrev_b32 v30, 16, v82
  v_and_b32 v31, 0xffff0000, v82
  v_pk_fma_f32 v[30:31], v[30:31], v[132:133], v[132:133] op_sel:[0,0,1] op_sel_hi:[1,0,1] neg_lo:[0,0,1] neg_hi:[0,0,1]
  v_cvt_pk_bf16_f32 v82, v30, v31
  v_lshlrev_b32 v30, 16, v83
  v_and_b32 v31, 0xffff0000, v83
  v_pk_fma_f32 v[30:31], v[30:31], v[132:133], v[132:133] op_sel:[0,0,1] op_sel_hi:[1,0,1] neg_lo:[0,0,1] neg_hi:[0,0,1]
  v_cvt_pk_bf16_f32 v83, v30, v31
  v_lshlrev_b32 v30, 16, v84
  v_and_b32 v31, 0xffff0000, v84
  v_pk_fma_f32 v[30:31], v[30:31], v[132:133], v[132:133] op_sel:[0,0,1] op_sel_hi:[1,0,1] neg_lo:[0,0,1] neg_hi:[0,0,1]
  v_cvt_pk_bf16_f32 v84, v30, v31
  v_lshlrev_b32 v30, 16, v85
  v_and_b32 v31, 0xffff0000, v85
  v_pk_fma_f32 v[30:31], v[30:31], v[132:133], v[132:133] op_sel:[0,0,1] op_sel_hi:[1,0,1] neg_lo:[0,0,1] neg_hi:[0,0,1]
  v_cvt_pk_bf16_f32 v85, v30, v31
  v_lshlrev_b32 v30, 16, v86
  v_and_b32 v31, 0xffff0000, v86
  v_pk_fma_f32 v[30:31], v[30:31], v[132:133], v[132:133] op_sel:[0,0,1] op_sel_hi:[1,0,1] neg_lo:[0,0,1] neg_hi:[0,0,1]
  v_cvt_pk_bf16_f32 v86, v30, v31
  v_lshlrev_b32 v30, 16, v87
  v_and_b32 v31, 0xffff0000, v87
  v_pk_fma_f32 v[30:31], v[30:31], v[132:133], v[132:133] op_sel:[0,0,1] op_sel_hi:[1,0,1] neg_lo:[0,0,1] neg_hi:[0,0,1]
  v_cvt_pk_bf16_f32 v87, v30, v31
  v_lshlrev_b32 v30, 16, v88
  v_and_b32 v31, 0xffff0000, v88
  v_pk_fma_f32 v[30:31], v[30:31], v[132:133], v[132:133] op_sel:[0,0,1] op_sel_hi:[1,0,1] neg_lo:[0,0,1] neg_hi:[0,0,1]
  v_cvt_pk_bf16_f32 v88, v30, v31
  v_lshlrev_b32 v30, 16, v89
  v_and_b32 v31, 0xffff0000, v89
  v_pk_fma_f32 v[30:31], v[30:31], v[132:133], v[132:133] op_sel:[0,0,1] op_sel_hi:[1,0,1] neg_lo:[0,0,1] neg_hi:[0,0,1]
  v_cvt_pk_bf16_f32 v89, v30, v31
  v_lshlrev_b32 v30, 16, v90
  v_and_b32 v31, 0xffff0000, v90
  v_pk_fma_f32 v[30:31], v[30:31], v[132:133], v[132:133] op_sel:[0,0,1] op_sel_hi:[1,0,1] neg_lo:[0,0,1] neg_hi:[0,0,1]
  v_cvt_pk_bf16_f32 v90, v30, v31
  v_lshlrev_b32 v30, 16, v91
  v_and_b32 v31, 0xffff0000, v91
  v_pk_fma_f32 v[30:31], v[30:31], v[132:133], v[132:133] op_sel:[0,0,1] op_sel_hi:[1,0,1] neg_lo:[0,0,1] neg_hi:[0,0,1]
  v_cvt_pk_bf16_f32 v91, v30, v31
  s_mov_b32 s35, 7946240
  buffer_store_dwordx4 v[72:75], v26, s[16:19], s35 offen offset:0 sc1
  buffer_store_dwordx4 v[76:79], v26, s[16:19], s35 offen offset:256 sc1
  buffer_store_dwordx4 v[80:83], v26, s[16:19], s35 offen offset:512 sc1
  buffer_store_dwordx4 v[84:87], v26, s[16:19], s35 offen offset:768 sc1
  buffer_store_dwordx4 v[88:91], v26, s[16:19], s35 offen offset:1024 sc1
  v_lshlrev_b32 v30, 16, v92
  v_and_b32 v31, 0xffff0000, v92
  v_pk_fma_f32 v[30:31], v[30:31], v[134:135], v[134:135] op_sel:[0,0,1] op_sel_hi:[1,0,1] neg_lo:[0,0,1] neg_hi:[0,0,1]
  v_cvt_pk_bf16_f32 v92, v30, v31
  v_lshlrev_b32 v30, 16, v93
  v_and_b32 v31, 0xffff0000, v93
  v_pk_fma_f32 v[30:31], v[30:31], v[134:135], v[134:135] op_sel:[0,0,1] op_sel_hi:[1,0,1] neg_lo:[0,0,1] neg_hi:[0,0,1]
  v_cvt_pk_bf16_f32 v93, v30, v31
  v_lshlrev_b32 v30, 16, v94
  v_and_b32 v31, 0xffff0000, v94
  v_pk_fma_f32 v[30:31], v[30:31], v[134:135], v[134:135] op_sel:[0,0,1] op_sel_hi:[1,0,1] neg_lo:[0,0,1] neg_hi:[0,0,1]
  v_cvt_pk_bf16_f32 v94, v30, v31
  v_lshlrev_b32 v30, 16, v95
  v_and_b32 v31, 0xffff0000, v95
  v_pk_fma_f32 v[30:31], v[30:31], v[134:135], v[134:135] op_sel:[0,0,1] op_sel_hi:[1,0,1] neg_lo:[0,0,1] neg_hi:[0,0,1]
  v_cvt_pk_bf16_f32 v95, v30, v31
  v_lshlrev_b32 v30, 16, v96
  v_and_b32 v31, 0xffff0000, v96
  v_pk_fma_f32 v[30:31], v[30:31], v[134:135], v[134:135] op_sel:[0,0,1] op_sel_hi:[1,0,1] neg_lo:[0,0,1] neg_hi:[0,0,1]
  v_cvt_pk_bf16_f32 v96, v30, v31
  v_lshlrev_b32 v30, 16, v97
  v_and_b32 v31, 0xffff0000, v97
  v_pk_fma_f32 v[30:31], v[30:31], v[134:135], v[134:135] op_sel:[0,0,1] op_sel_hi:[1,0,1] neg_lo:[0,0,1] neg_hi:[0,0,1]
  v_cvt_pk_bf16_f32 v97, v30, v31
  v_lshlrev_b32 v30, 16, v98
  v_and_b32 v31, 0xffff0000, v98
  v_pk_fma_f32 v[30:31], v[30:31], v[134:135], v[134:135] op_sel:[0,0,1] op_sel_hi:[1,0,1] neg_lo:[0,0,1] neg_hi:[0,0,1]
  v_cvt_pk_bf16_f32 v98, v30, v31
  v_lshlrev_b32 v30, 16, v99
  v_and_b32 v31, 0xffff0000, v99
  v_pk_fma_f32 v[30:31], v[30:31], v[134:135], v[134:135] op_sel:[0,0,1] op_sel_hi:[1,0,1] neg_lo:[0,0,1] neg_hi:[0,0,1]
  v_cvt_pk_bf16_f32 v99, v30, v31
  v_lshlrev_b32 v30, 16, v100
  v_and_b32 v31, 0xffff0000, v100
  v_pk_fma_f32 v[30:31], v[30:31], v[134:135], v[134:135] op_sel:[0,0,1] op_sel_hi:[1,0,1] neg_lo:[0,0,1] neg_hi:[0,0,1]
  v_cvt_pk_bf16_f32 v100, v30, v31
  v_lshlrev_b32 v30, 16, v101
  v_and_b32 v31, 0xffff0000, v101
  v_pk_fma_f32 v[30:31], v[30:31], v[134:135], v[134:135] op_sel:[0,0,1] op_sel_hi:[1,0,1] neg_lo:[0,0,1] neg_hi:[0,0,1]
  v_cvt_pk_bf16_f32 v101, v30, v31
  v_lshlrev_b32 v30, 16, v102
  v_and_b32 v31, 0xffff0000, v102
  v_pk_fma_f32 v[30:31], v[30:31], v[134:135], v[134:135] op_sel:[0,0,1] op_sel_hi:[1,0,1] neg_lo:[0,0,1] neg_hi:[0,0,1]
  v_cvt_pk_bf16_f32 v102, v30, v31
  v_lshlrev_b32 v30, 16, v103
  v_and_b32 v31, 0xffff0000, v103
  v_pk_fma_f32 v[30:31], v[30:31], v[134:135], v[134:135] op_sel:[0,0,1] op_sel_hi:[1,0,1] neg_lo:[0,0,1] neg_hi:[0,0,1]
  v_cvt_pk_bf16_f32 v103, v30, v31
  v_lshlrev_b32 v30, 16, v104
  v_and_b32 v31, 0xffff0000, v104
  v_pk_fma_f32 v[30:31], v[30:31], v[134:135], v[134:135] op_sel:[0,0,1] op_sel_hi:[1,0,1] neg_lo:[0,0,1] neg_hi:[0,0,1]
  v_cvt_pk_bf16_f32 v104, v30, v31
  v_lshlrev_b32 v30, 16, v105
  v_and_b32 v31, 0xffff0000, v105
  v_pk_fma_f32 v[30:31], v[30:31], v[134:135], v[134:135] op_sel:[0,0,1] op_sel_hi:[1,0,1] neg_lo:[0,0,1] neg_hi:[0,0,1]
  v_cvt_pk_bf16_f32 v105, v30, v31
  v_lshlrev_b32 v30, 16, v106
  v_and_b32 v31, 0xffff0000, v106
  v_pk_fma_f32 v[30:31], v[30:31], v[134:135], v[134:135] op_sel:[0,0,1] op_sel_hi:[1,0,1] neg_lo:[0,0,1] neg_hi:[0,0,1]
  v_cvt_pk_bf16_f32 v106, v30, v31
  v_lshlrev_b32 v30, 16, v107
  v_and_b32 v31, 0xffff0000, v107
  v_pk_fma_f32 v[30:31], v[30:31], v[134:135], v[134:135] op_sel:[0,0,1] op_sel_hi:[1,0,1] neg_lo:[0,0,1] neg_hi:[0,0,1]
  v_cvt_pk_bf16_f32 v107, v30, v31
  v_lshlrev_b32 v30, 16, v108
  v_and_b32 v31, 0xffff0000, v108
  v_pk_fma_f32 v[30:31], v[30:31], v[134:135], v[134:135] op_sel:[0,0,1] op_sel_hi:[1,0,1] neg_lo:[0,0,1] neg_hi:[0,0,1]
  v_cvt_pk_bf16_f32 v108, v30, v31
  v_lshlrev_b32 v30, 16, v109
  v_and_b32 v31, 0xffff0000, v109
  v_pk_fma_f32 v[30:31], v[30:31], v[134:135], v[134:135] op_sel:[0,0,1] op_sel_hi:[1,0,1] neg_lo:[0,0,1] neg_hi:[0,0,1]
  v_cvt_pk_bf16_f32 v109, v30, v31
  v_lshlrev_b32 v30, 16, v110
  v_and_b32 v31, 0xffff0000, v110
  v_pk_fma_f32 v[30:31], v[30:31], v[134:135], v[134:135] op_sel:[0,0,1] op_sel_hi:[1,0,1] neg_lo:[0,0,1] neg_hi:[0,0,1]
  v_cvt_pk_bf16_f32 v110, v30, v31
  v_lshlrev_b32 v30, 16, v111
  v_and_b32 v31, 0xffff0000, v111
  v_pk_fma_f32 v[30:31], v[30:31], v[134:135], v[134:135] op_sel:[0,0,1] op_sel_hi:[1,0,1] neg_lo:[0,0,1] neg_hi:[0,0,1]
  v_cvt_pk_bf16_f32 v111, v30, v31
  s_mov_b32 s35, 7987200
  buffer_store_dwordx4 v[92:95], v26, s[16:19], s35 offen offset:0 sc1
  buffer_store_dwordx4 v[96:99], v26, s[16:19], s35 offen offset:256 sc1
  buffer_store_dwordx4 v[100:103], v26, s[16:19], s35 offen offset:512 sc1
  buffer_store_dwordx4 v[104:107], v26, s[16:19], s35 offen offset:768 sc1
  buffer_store_dwordx4 v[108:111], v26, s[16:19], s35 offen offset:1024 sc1
  s_branch La_ln_end
La_ln_w0:
  s_waitcnt vmcnt(15)
  v_dot2c_f32_bf16 v112, v27, v32
  v_dot2c_f32_bf16 v113, v32, v32
  v_dot2c_f32_bf16 v112, v27, v33
  v_dot2c_f32_bf16 v113, v33, v33
  v_dot2c_f32_bf16 v112, v27, v34
  v_dot2c_f32_bf16 v113, v34, v34
  v_dot2c_f32_bf16 v112, v27, v35
  v_dot2c_f32_bf16 v113, v35, v35
  v_dot2c_f32_bf16 v112, v27, v36
  v_dot2c_f32_bf16 v113, v36, v36
  v_dot2c_f32_bf16 v112, v27, v37
  v_dot2c_f32_bf16 v113, v37, v37
  v_dot2c_f32_bf16 v112, v27, v38
  v_dot2c_f32_bf16 v113, v38, v38
  v_dot2c_f32_bf16 v112, v27, v39
  v_dot2c_f32_bf16 v113, v39, v39
  v_dot2c_f32_bf16 v112, v27, v40
  v_dot2c_f32_bf16 v113, v40, v40
  v_dot2c_f32_bf16 v112, v27, v41
  v_dot2c_f32_bf16 v113, v41, v41
  v_dot2c_f32_bf16 v112, v27, v42
  v_dot2c_f32_bf16 v113, v42, v42
  v_dot2c_f32_bf16 v112, v27, v43
  v_dot2c_f32_bf16 v113, v43, v43
  v_dot2c_f32_bf16 v112, v27, v44
  v_dot2c_f32_bf16 v113, v44, v44
  v_dot2c_f32_bf16 v112, v27, v45
  v_dot2c_f32_bf16 v113, v45, v45
  v_dot2c_f32_bf16 v112, v27, v46
  v_dot2c_f32_bf16 v113, v46, v46
  v_dot2c_f32_bf16 v112, v27, v47
  v_dot2c_f32_bf16 v113, v47, v47
  v_dot2c_f32_bf16 v112, v27, v48
  v_dot2c_f32_bf16 v113, v48, v48
  v_dot2c_f32_bf16 v112, v27, v49
  v_dot2c_f32_bf16 v113, v49, v49
  v_dot2c_f32_bf16 v112, v27, v50
  v_dot2c_f32_bf16 v113, v50, v50
  v_dot2c_f32_bf16 v112, v27, v51
  v_dot2c_f32_bf16 v113, v51, v51
  s_nop 2
  v_add_f32_dpp v112, v112, v112 row_ror:8 row_mask:0xf bank_mask:0xf
  v_add_f32_dpp v113, v113, v113 row_ror:8 row_mask:0xf bank_mask:0xf
  s_nop 0
  v_add_f32_dpp v112, v112, v112 row_ror:4 row_mask:0xf bank_mask:0xf
  v_add_f32_dpp v113, v113, v113 row_ror:4 row_mask:0xf bank_mask:0xf
  s_nop 0
  v_add_f32_dpp v112, v112, v112 row_ror:2 row_mask:0xf bank_mask:0xf
  v_add_f32_dpp v113, v113, v113 row_ror:2 row_mask:0xf bank_mask:0xf
  s_nop 0
  v_add_f32_dpp v112, v112, v112 row_ror:1 row_mask:0xf bank_mask:0xf
  v_add_f32_dpp v113, v113, v113 row_ror:1 row_mask:0xf bank_mask:0xf
  s_nop 0
  v_mul_f32 v120, 0x3acccccd, v112
  v_mul_f32 v30, 0x3acccccd, v113
  v_fma_f32 v30, -v120, v120, v30
  v_max_f32 v30, 0, v30
  v_add_f32 v31, 0x3727c5ac, v30
  v_rsq_f32 v121, v31
  s_nop 0
  v_mul_f32 v31, v121, v121
  v_mul_f32 v31, v31, v30
  v_add_f32 v31, 0x3727c5ac, v31
  v_rsq_f32 v31, v31
  s_nop 0
  v_mul_f32 v128, v31, v121
  v_mul_f32 v129, v128, v120
  s_mov_b64 exec, s[38:39]
  ds_write_b64 v29, v[120:121] offset:0
  s_mov_b64 exec, -1
  s_waitcnt vmcnt(10)
  v_dot2c_f32_bf16 v114, v27, v52
  v_dot2c_f32_bf16 v115, v52, v52
  v_dot2c_f32_bf16 v114, v27, v53
  v_dot2c_f32_bf16 v115, v53, v53
  v_dot2c_f32_bf16 v114, v27, v54
  v_dot2c_f32_bf16 v115, v54, v54
  v_dot2c_f32_bf16 v114, v27, v55
  v_dot2c_f32_bf16 v115, v55, v55
  v_dot2c_f32_bf16 v114, v27, v56
  v_dot2c_f32_bf16 v115, v56, v56
  v_dot2c_f32_bf16 v114, v27, v57
  v_dot2c_f32_bf16 v115, v57, v57
  v_dot2c_f32_bf16 v114, v27, v58
  v_dot2c_f32_bf16 v115, v58, v58
  v_dot2c_f32_bf16 v114, v27, v59
  v_dot2c_f32_bf16 v115, v59, v59
  v_dot2c_f32_bf16 v114, v27, v60
  v_dot2c_f32_bf16 v115, v60, v60
  v_dot2c_f32_bf16 v114, v27, v61
  v_dot2c_f32_bf16 v115, v61, v61
  v_dot2c_f32_bf16 v114, v27, v62
  v_dot2c_f32_bf16 v115, v62, v62
  v_dot2c_f32_bf16 v114, v27, v63
  v_dot2c_f32_bf16 v115, v63, v63
  v_dot2c_f32_bf16 v114, v27, v64
  v_dot2c_f32_bf16 v115, v64, v64
  v_dot2c_f32_bf16 v114, v27, v65
  v_dot2c_f32_bf16 v115, v65, v65
  v_dot2c_f32_bf16 v114, v27, v66
  v_dot2c_f32_bf16 v115, v66, v66
  v_dot2c_f32_bf16 v114, v27, v67
  v_dot2c_f32_bf16 v115, v67, v67
  v_dot2c_f32_bf16 v114, v27, v68
  v_dot2c_f32_bf16 v115, v68, v68
  v_dot2c_f32_bf16 v114, v27, v69
  v_dot2c_f32_bf16 v115, v69, v69
  v_dot2c_f32_bf16 v114, v27, v70
  v_dot2c_f32_bf16 v115, v70, v70
  v_dot2c_f32_bf16 v114, v27, v71
  v_dot2c_f32_bf16 v115, v71, v71
  s_nop 2
  v_add_f32_dpp v114, v114, v114 row_ror:8 row_mask:0xf bank_mask:0xf
  v_add_f32_dpp v115, v115, v115 row_ror:8 row_mask:0xf bank_mask:0xf
  s_nop 0
  v_add_f32_dpp v114, v114, v114 row_ror:4 row_mask:0xf bank_mask:0xf
  v_add_f32_dpp v115, v115, v115 row_ror:4 row_mask:0xf bank_mask:0xf
  s_nop 0
  v_add_f32_dpp v114, v114, v114 row_ror:2 row_mask:0xf bank_mask:0xf
  v_add_f32_dpp v115, v115, v115 row_ror:2 row_mask:0xf bank_mask:0xf
  s_nop 0
  v_add_f32_dpp v114, v114, v114 row_ror:1 row_mask:0xf bank_mask:0xf
  v_add_f32_dpp v115, v115, v115 row_ror:1 row_mask:0xf bank_mask:0xf
  s_nop 0
  v_mul_f32 v122, 0x3acccccd, v114
  v_mul_f32 v30, 0x3acccccd, v115
  v_fma_f32 v30, -v122, v122, v30
  v_max_f32 v30, 0, v30
  v_add_f32 v31, 0x3727c5ac, v30
  v_rsq_f32 v123, v31
  s_nop 0
  v_mul_f32 v31, v123, v123
  v_mul_f32 v31, v31, v30
  v_add_f32 v31, 0x3727c5ac, v31
  v_rsq_f32 v31, v31
  s_nop 0
  v_mul_f32 v130, v31, v123
  v_mul_f32 v131, v130, v122
  s_mov_b64 exec, s[38:39]
  ds_write_b64 v29, v[122:123] offset:256
  s_mov_b64 exec, -1
  s_waitcnt vmcnt(5)
  v_dot2c_f32_bf16 v116, v27, v72
  v_dot2c_f32_bf16 v117, v72, v72
  v_dot2c_f32_bf16 v116, v27, v73
  v_dot2c_f32_bf16 v117, v73, v73
  v_dot2c_f32_bf16 v116, v27, v74
  v_dot2c_f32_bf16 v117, v74, v74
  v_dot2c_f32_bf16 v116, v27, v75
  v_dot2c_f32_bf16 v117, v75, v75
  v_dot2c_f32_bf16 v116, v27, v76
  v_dot2c_f32_bf16 v117, v76, v76
  v_dot2c_f32_bf16 v116, v27, v77
  v_dot2c_f32_bf16 v117, v77, v77
  v_dot2c_f32_bf16 v116, v27, v78
  v_dot2c_f32_bf16 v117, v78, v78
  v_dot2c_f32_bf16 v116, v27, v79
  v_dot2c_f32_bf16 v117, v79, v79
  v_dot2c_f32_bf16 v116, v27, v80
  v_dot2c_f32_bf16 v117, v80, v80
  v_dot2c_f32_bf16 v116, v27, v81
  v_dot2c_f32_bf16 v117, v81, v81
  v_dot2c_f32_bf16 v116, v27, v82
  v_dot2c_f32_bf16 v117, v82, v82
  v_dot2c_f32_bf16 v116, v27, v83
  v_dot2c_f32_bf16 v117, v83, v83
  v_dot2c_f32_bf16 v116, v27, v84
  v_dot2c_f32_bf16 v117, v84, v84
  v_dot2c_f32_bf16 v116, v27, v85
  v_dot2c_f32_bf16 v117, v85, v85
  v_dot2c_f32_bf16 v116, v27, v86
  v_dot2c_f32_bf16 v117, v86, v86
  v_dot2c_f32_bf16 v116, v27, v87
  v_dot2c_f32_bf16 v117, v87, v87
  v_dot2c_f32_bf16 v116, v27, v88
  v_dot2c_f32_bf16 v117, v88, v88
  v_dot2c_f32_bf16 v116, v27, v89
  v_dot2c_f32_bf16 v117, v89, v89
  v_dot2c_f32_bf16 v116, v27, v90
  v_dot2c_f32_bf16 v117, v90, v90
  v_dot2c_f32_bf16 v116, v27, v91
  v_dot2c_f32_bf16 v117, v91, v91
  s_nop 2
  v_add_f32_dpp v116, v116, v116 row_ror:8 row_mask:0xf bank_mask:0xf
  v_add_f32_dpp v117, v117, v117 row_ror:8 row_mask:0xf bank_mask:0xf
  s_nop 0
  v_add_f32_dpp v116, v116, v116 row_ror:4 row_mask:0xf bank_mask:0xf
  v_add_f32_dpp v117, v117, v117 row_ror:4 row_mask:0xf bank_mask:0xf
  s_nop 0
  v_add_f32_dpp v116, v116, v116 row_ror:2 row_mask:0xf bank_mask:0xf
  v_add_f32_dpp v117, v117, v117 row_ror:2 row_mask:0xf bank_mask:0xf
  s_nop 0
  v_add_f32_dpp v116, v116, v116 row_ror:1 row_mask:0xf bank_mask:0xf
  v_add_f32_dpp v117, v117, v117 row_ror:1 row_mask:0xf bank_mask:0xf
  s_nop 0
  v_mul_f32 v124, 0x3acccccd, v116
  v_mul_f32 v30, 0x3acccccd, v117
  v_fma_f32 v30, -v124, v124, v30
  v_max_f32 v30, 0, v30
  v_add_f32 v31, 0x3727c5ac, v30
  v_rsq_f32 v125, v31
  s_nop 0
  v_mul_f32 v31, v125, v125
  v_mul_f32 v31, v31, v30
  v_add_f32 v31, 0x3727c5ac, v31
  v_rsq_f32 v31, v31
  s_nop 0
  v_mul_f32 v132, v31, v125
  v_mul_f32 v133, v132, v124
  s_mov_b64 exec, s[38:39]
  ds_write_b64 v29, v[124:125] offset:512
  s_mov_b64 exec, -1
  s_waitcnt vmcnt(0)
  v_dot2c_f32_bf16 v118, v27, v92
  v_dot2c_f32_bf16 v119, v92, v92
  v_dot2c_f32_bf16 v118, v27, v93
  v_dot2c_f32_bf16 v119, v93, v93
  v_dot2c_f32_bf16 v118, v27, v94
  v_dot2c_f32_bf16 v119, v94, v94
  v_dot2c_f32_bf16 v118, v27, v95
  v_dot2c_f32_bf16 v119, v95, v95
  v_dot2c_f32_bf16 v118, v27, v96
  v_dot2c_f32_bf16 v119, v96, v96
  v_dot2c_f32_bf16 v118, v27, v97
  v_dot2c_f32_bf16 v119, v97, v97
  v_dot2c_f32_bf16 v118, v27, v98
  v_dot2c_f32_bf16 v119, v98, v98
  v_dot2c_f32_bf16 v118, v27, v99
  v_dot2c_f32_bf16 v119, v99, v99
  v_dot2c_f32_bf16 v118, v27, v100
  v_dot2c_f32_bf16 v119, v100, v100
  v_dot2c_f32_bf16 v118, v27, v101
  v_dot2c_f32_bf16 v119, v101, v101
  v_dot2c_f32_bf16 v118, v27, v102
  v_dot2c_f32_bf16 v119, v102, v102
  v_dot2c_f32_bf16 v118, v27, v103
  v_dot2c_f32_bf16 v119, v103, v103
  v_dot2c_f32_bf16 v118, v27, v104
  v_dot2c_f32_bf16 v119, v104, v104
  v_dot2c_f32_bf16 v118, v27, v105
  v_dot2c_f32_bf16 v119, v105, v105
  v_dot2c_f32_bf16 v118, v27, v106
  v_dot2c_f32_bf16 v119, v106, v106
  v_dot2c_f32_bf16 v118, v27, v107
  v_dot2c_f32_bf16 v119, v107, v107
  v_dot2c_f32_bf16 v118, v27, v108
  v_dot2c_f32_bf16 v119, v108, v108
  v_dot2c_f32_bf16 v118, v27, v109
  v_dot2c_f32_bf16 v119, v109, v109
  v_dot2c_f32_bf16 v118, v27, v110
  v_dot2c_f32_bf16 v119, v110, v110
  v_dot2c_f32_bf16 v118, v27, v111
  v_dot2c_f32_bf16 v119, v111, v111
  s_nop 2
  v_add_f32_dpp v118, v118, v118 row_ror:8 row_mask:0xf bank_mask:0xf
  v_add_f32_dpp v119, v119, v119 row_ror:8 row_mask:0xf bank_mask:0xf
  s_nop 0
  v_add_f32_dpp v118, v118, v118 row_ror:4 row_mask:0xf bank_mask:0xf
  v_add_f32_dpp v119, v119, v119 row_ror:4 row_mask:0xf bank_mask:0xf
  s_nop 0
  v_add_f32_dpp v118, v118, v118 row_ror:2 row_mask:0xf bank_mask:0xf
  v_add_f32_dpp v119, v119, v119 row_ror:2 row_mask:0xf bank_mask:0xf
  s_nop 0
  v_add_f32_dpp v118, v118, v118 row_ror:1 row_mask:0xf bank_mask:0xf
  v_add_f32_dpp v119, v119, v119 row_ror:1 row_mask:0xf bank_mask:0xf
  s_nop 0
  v_mul_f32 v126, 0x3acccccd, v118
  v_mul_f32 v30, 0x3acccccd, v119
  v_fma_f32 v30, -v126, v126, v30
  v_max_f32 v30, 0, v30
  v_add_f32 v31, 0x3727c5ac, v30
  v_rsq_f32 v127, v31
  s_nop 0
  v_mul_f32 v31, v127, v127
  v_mul_f32 v31, v31, v30
  v_add_f32 v31, 0x3727c5ac, v31
  v_rsq_f32 v31, v31
  s_nop 0
  v_mul_f32 v134, v31, v127
  v_mul_f32 v135, v134, v126
  s_mov_b64 exec, s[38:39]
  ds_write_b64 v29, v[126:127] offset:768
  s_mov_b64 exec, -1
  s_waitcnt lgkmcnt(0)
  s_barrier
  v_lshlrev_b32 v30, 4, v1
  ds_read_b128 v[112:115], v30
  s_lshl_b32 s33, s25, 10
  s_add_u32 s33, s33, 16252928
  s_waitcnt lgkmcnt(0)
  buffer_store_dwordx4 v[112:115], v30, s[16:19], s33 offen sc1
  s_nop 1
  v_lshlrev_b32 v30, 16, v32
  v_and_b32 v31, 0xffff0000, v32
  v_pk_fma_f32 v[30:31], v[30:31], v[128:129], v[128:129] op_sel:[0,0,1] op_sel_hi:[1,0,1] neg_lo:[0,0,1] neg_hi:[0,0,1]
  v_cvt_pk_bf16_f32 v32, v30, v31
  v_lshlrev_b32 v30, 16, v33
  v_and_b32 v31, 0xffff0000, v33
  v_pk_fma_f32 v[30:31], v[30:31], v[128:129], v[128:129] op_sel:[0,0,1] op_sel_hi:[1,0,1] neg_lo:[0,0,1] neg_hi:[0,0,1]
  v_cvt_pk_bf16_f32 v33, v30, v31
  v_lshlrev_b32 v30, 16, v34
  v_and_b32 v31, 0xffff0000, v34
  v_pk_fma_f32 v[30:31], v[30:31], v[128:129], v[128:129] op_sel:[0,0,1] op_sel_hi:[1,0,1] neg_lo:[0,0,1] neg_hi:[0,0,1]
  v_cvt_pk_bf16_f32 v34, v30, v31
  v_lshlrev_b32 v30, 16, v35
  v_and_b32 v31, 0xffff0000, v35
  v_pk_fma_f32 v[30:31], v[30:31], v[128:129], v[128:129] op_sel:[0,0,1] op_sel_hi:[1,0,1] neg_lo:[0,0,1] neg_hi:[0,0,1]
  v_cvt_pk_bf16_f32 v35, v30, v31
  v_lshlrev_b32 v30, 16, v36
  v_and_b32 v31, 0xffff0000, v36
  v_pk_fma_f32 v[30:31], v[30:31], v[128:129], v[128:129] op_sel:[0,0,1] op_sel_hi:[1,0,1] neg_lo:[0,0,1] neg_hi:[0,0,1]
  v_cvt_pk_bf16_f32 v36, v30, v31
  v_lshlrev_b32 v30, 16, v37
  v_and_b32 v31, 0xffff0000, v37
  v_pk_fma_f32 v[30:31], v[30:31], v[128:129], v[128:129] op_sel:[0,0,1] op_sel_hi:[1,0,1] neg_lo:[0,0,1] neg_hi:[0,0,1]
  v_cvt_pk_bf16_f32 v37, v30, v31
  v_lshlrev_b32 v30, 16, v38
  v_and_b32 v31, 0xffff0000, v38
  v_pk_fma_f32 v[30:31], v[30:31], v[128:129], v[128:129] op_sel:[0,0,1] op_sel_hi:[1,0,1] neg_lo:[0,0,1] neg_hi:[0,0,1]
  v_cvt_pk_bf16_f32 v38, v30, v31
  v_lshlrev_b32 v30, 16, v39
  v_and_b32 v31, 0xffff0000, v39
  v_pk_fma_f32 v[30:31], v[30:31], v[128:129], v[128:129] op_sel:[0,0,1] op_sel_hi:[1,0,1] neg_lo:[0,0,1] neg_hi:[0,0,1]
  v_cvt_pk_bf16_f32 v39, v30, v31
  v_lshlrev_b32 v30, 16, v40
  v_and_b32 v31, 0xffff0000, v40
  v_pk_fma_f32 v[30:31], v[30:31], v[128:129], v[128:129] op_sel:[0,0,1] op_sel_hi:[1,0,1] neg_lo:[0,0,1] neg_hi:[0,0,1]
  v_cvt_pk_bf16_f32 v40, v30, v31
  v_lshlrev_b32 v30, 16, v41
  v_and_b32 v31, 0xffff0000, v41
  v_pk_fma_f32 v[30:31], v[30:31], v[128:129], v[128:129] op_sel:[0,0,1] op_sel_hi:[1,0,1] neg_lo:[0,0,1] neg_hi:[0,0,1]
  v_cvt_pk_bf16_f32 v41, v30, v31
  v_lshlrev_b32 v30, 16, v42
  v_and_b32 v31, 0xffff0000, v42
  v_pk_fma_f32 v[30:31], v[30:31], v[128:129], v[128:129] op_sel:[0,0,1] op_sel_hi:[1,0,1] neg_lo:[0,0,1] neg_hi:[0,0,1]
  v_cvt_pk_bf16_f32 v42, v30, v31
  v_lshlrev_b32 v30, 16, v43
  v_and_b32 v31, 0xffff0000, v43
  v_pk_fma_f32 v[30:31], v[30:31], v[128:129], v[128:129] op_sel:[0,0,1] op_sel_hi:[1,0,1] neg_lo:[0,0,1] neg_hi:[0,0,1]
  v_cvt_pk_bf16_f32 v43, v30, v31
  v_lshlrev_b32 v30, 16, v44
  v_and_b32 v31, 0xffff0000, v44
  v_pk_fma_f32 v[30:31], v[30:31], v[128:129], v[128:129] op_sel:[0,0,1] op_sel_hi:[1,0,1] neg_lo:[0,0,1] neg_hi:[0,0,1]
  v_cvt_pk_bf16_f32 v44, v30, v31
  v_lshlrev_b32 v30, 16, v45
  v_and_b32 v31, 0xffff0000, v45
  v_pk_fma_f32 v[30:31], v[30:31], v[128:129], v[128:129] op_sel:[0,0,1] op_sel_hi:[1,0,1] neg_lo:[0,0,1] neg_hi:[0,0,1]
  v_cvt_pk_bf16_f32 v45, v30, v31
  v_lshlrev_b32 v30, 16, v46
  v_and_b32 v31, 0xffff0000, v46
  v_pk_fma_f32 v[30:31], v[30:31], v[128:129], v[128:129] op_sel:[0,0,1] op_sel_hi:[1,0,1] neg_lo:[0,0,1] neg_hi:[0,0,1]
  v_cvt_pk_bf16_f32 v46, v30, v31
  v_lshlrev_b32 v30, 16, v47
  v_and_b32 v31, 0xffff0000, v47
  v_pk_fma_f32 v[30:31], v[30:31], v[128:129], v[128:129] op_sel:[0,0,1] op_sel_hi:[1,0,1] neg_lo:[0,0,1] neg_hi:[0,0,1]
  v_cvt_pk_bf16_f32 v47, v30, v31
  v_lshlrev_b32 v30, 16, v48
  v_and_b32 v31, 0xffff0000, v48
  v_pk_fma_f32 v[30:31], v[30:31], v[128:129], v[128:129] op_sel:[0,0,1] op_sel_hi:[1,0,1] neg_lo:[0,0,1] neg_hi:[0,0,1]
  v_cvt_pk_bf16_f32 v48, v30, v31
  v_lshlrev_b32 v30, 16, v49
  v_and_b32 v31, 0xffff0000, v49
  v_pk_fma_f32 v[30:31], v[30:31], v[128:129], v[128:129] op_sel:[0,0,1] op_sel_hi:[1,0,1] neg_lo:[0,0,1] neg_hi:[0,0,1]
  v_cvt_pk_bf16_f32 v49, v30, v31
  v_lshlrev_b32 v30, 16, v50
  v_and_b32 v31, 0xffff0000, v50
  v_pk_fma_f32 v[30:31], v[30:31], v[128:129], v[128:129] op_sel:[0,0,1] op_sel_hi:[1,0,1] neg_lo:[0,0,1] neg_hi:[0,0,1]
  v_cvt_pk_bf16_f32 v50, v30, v31
  v_lshlrev_b32 v30, 16, v51
  v_and_b32 v31, 0xffff0000, v51
  v_pk_fma_f32 v[30:31], v[30:31], v[128:129], v[128:129] op_sel:[0,0,1] op_sel_hi:[1,0,1] neg_lo:[0,0,1] neg_hi:[0,0,1]
  v_cvt_pk_bf16_f32 v51, v30, v31
  s_waitcnt vmcnt(0)
  s_lshl_b32 s33, s25, 2
  s_add_u32 s33, s33, 128
  v_mov_b32 v30, s33
  v_mov_b32 v31, 1
  s_mov_b64 exec, 1
  buffer_store_dword v31, v30, s[44:47], 0 offen sc1
  s_mov_b64 exec, -1
  s_mov_b32 s35, 7864320
  buffer_store_dwordx4 v[32:35], v26, s[16:19], s35 offen offset:0 sc1
  buffer_store_dwordx4 v[36:39], v26, s[16:19], s35 offen offset:256 sc1
  buffer_store_dwordx4 v[40:43], v26, s[16:19], s35 offen offset:512 sc1
  buffer_store_dwordx4 v[44:47], v26, s[16:19], s35 offen offset:768 sc1
  buffer_store_dwordx4 v[48:51], v26, s[16:19], s35 offen offset:1024 sc1
  v_lshlrev_b32 v30, 16, v52
  v_and_b32 v31, 0xffff0000, v52
  v_pk_fma_f32 v[30:31], v[30:31], v[130:131], v[130:131] op_sel:[0,0,1] op_sel_hi:[1,0,1] neg_lo:[0,0,1] neg_hi:[0,0,1]
  v_cvt_pk_bf16_f32 v52, v30, v31
  v_lshlrev_b32 v30, 16, v53
  v_and_b32 v31, 0xffff0000, v53
  v_pk_fma_f32 v[30:31], v[30:31], v[130:131], v[130:131] op_sel:[0,0,1] op_sel_hi:[1,0,1] neg_lo:[0,0,1] neg_hi:[0,0,1]
  v_cvt_pk_bf16_f32 v53, v30, v31
  v_lshlrev_b32 v30, 16, v54
  v_and_b32 v31, 0xffff0000, v54
  v_pk_fma_f32 v[30:31], v[30:31], v[130:131], v[130:131] op_sel:[0,0,1] op_sel_hi:[1,0,1] neg_lo:[0,0,1] neg_hi:[0,0,1]
  v_cvt_pk_bf16_f32 v54, v30, v31
  v_lshlrev_b32 v30, 16, v55
  v_and_b32 v31, 0xffff0000, v55
  v_pk_fma_f32 v[30:31], v[30:31], v[130:131], v[130:131] op_sel:[0,0,1] op_sel_hi:[1,0,1] neg_lo:[0,0,1] neg_hi:[0,0,1]
  v_cvt_pk_bf16_f32 v55, v30, v31
  v_lshlrev_b32 v30, 16, v56
  v_and_b32 v31, 0xffff0000, v56
  v_pk_fma_f32 v[30:31], v[30:31], v[130:131], v[130:131] op_sel:[0,0,1] op_sel_hi:[1,0,1] neg_lo:[0,0,1] neg_hi:[0,0,1]
  v_cvt_pk_bf16_f32 v56, v30, v31
  v_lshlrev_b32 v30, 16, v57
  v_and_b32 v31, 0xffff0000, v57
  v_pk_fma_f32 v[30:31], v[30:31], v[130:131], v[130:131] op_sel:[0,0,1] op_sel_hi:[1,0,1] neg_lo:[0,0,1] neg_hi:[0,0,1]
  v_cvt_pk_bf16_f32 v57, v30, v31
  v_lshlrev_b32 v30, 16, v58
  v_and_b32 v31, 0xffff0000, v58
  v_pk_fma_f32 v[30:31], v[30:31], v[130:131], v[130:131] op_sel:[0,0,1] op_sel_hi:[1,0,1] neg_lo:[0,0,1] neg_hi:[0,0,1]
  v_cvt_pk_bf16_f32 v58, v30, v31
  v_lshlrev_b32 v30, 16, v59
  v_and_b32 v31, 0xffff0000, v59
  v_pk_fma_f32 v[30:31], v[30:31], v[130:131], v[130:131] op_sel:[0,0,1] op_sel_hi:[1,0,1] neg_lo:[0,0,1] neg_hi:[0,0,1]
  v_cvt_pk_bf16_f32 v59, v30, v31
  v_lshlrev_b32 v30, 16, v60
  v_and_b32 v31, 0xffff0000, v60
  v_pk_fma_f32 v[30:31], v[30:31], v[130:131], v[130:131] op_sel:[0,0,1] op_sel_hi:[1,0,1] neg_lo:[0,0,1] neg_hi:[0,0,1]
  v_cvt_pk_bf16_f32 v60, v30, v31
  v_lshlrev_b32 v30, 16, v61
  v_and_b32 v31, 0xffff0000, v61
  v_pk_fma_f32 v[30:31], v[30:31], v[130:131], v[130:131] op_sel:[0,0,1] op_sel_hi:[1,0,1] neg_lo:[0,0,1] neg_hi:[0,0,1]
  v_cvt_pk_bf16_f32 v61, v30, v31
  v_lshlrev_b32 v30, 16, v62
  v_and_b32 v31, 0xffff0000, v62
  v_pk_fma_f32 v[30:31], v[30:31], v[130:131], v[130:131] op_sel:[0,0,1] op_sel_hi:[1,0,1] neg_lo:[0,0,1] neg_hi:[0,0,1]
  v_cvt_pk_bf16_f32 v62, v30, v31
  v_lshlrev_b32 v30, 16, v63
  v_and_b32 v31, 0xffff0000, v63
  v_pk_fma_f32 v[30:31], v[30:31], v[130:131], v[130:131] op_sel:[0,0,1] op_sel_hi:[1,0,1] neg_lo:[0,0,1] neg_hi:[0,0,1]
  v_cvt_pk_bf16_f32 v63, v30, v31
  v_lshlrev_b32 v30, 16, v64
  v_and_b32 v31, 0xffff0000, v64
  v_pk_fma_f32 v[30:31], v[30:31], v[130:131], v[130:131] op_sel:[0,0,1] op_sel_hi:[1,0,1] neg_lo:[0,0,1] neg_hi:[0,0,1]
  v_cvt_pk_bf16_f32 v64, v30, v31
  v_lshlrev_b32 v30, 16, v65
  v_and_b32 v31, 0xffff0000, v65
  v_pk_fma_f32 v[30:31], v[30:31], v[130:131], v[130:131] op_sel:[0,0,1] op_sel_hi:[1,0,1] neg_lo:[0,0,1] neg_hi:[0,0,1]
  v_cvt_pk_bf16_f32 v65, v30, v31
  v_lshlrev_b32 v30, 16, v66
  v_and_b32 v31, 0xffff0000, v66
  v_pk_fma_f32 v[30:31], v[30:31], v[130:131], v[130:131] op_sel:[0,0,1] op_sel_hi:[1,0,1] neg_lo:[0,0,1] neg_hi:[0,0,1]
  v_cvt_pk_bf16_f32 v66, v30, v31
  v_lshlrev_b32 v30, 16, v67
  v_and_b32 v31, 0xffff0000, v67
  v_pk_fma_f32 v[30:31], v[30:31], v[130:131], v[130:131] op_sel:[0,0,1] op_sel_hi:[1,0,1] neg_lo:[0,0,1] neg_hi:[0,0,1]
  v_cvt_pk_bf16_f32 v67, v30, v31
  v_lshlrev_b32 v30, 16, v68
  v_and_b32 v31, 0xffff0000, v68
  v_pk_fma_f32 v[30:31], v[30:31], v[130:131], v[130:131] op_sel:[0,0,1] op_sel_hi:[1,0,1] neg_lo:[0,0,1] neg_hi:[0,0,1]
  v_cvt_pk_bf16_f32 v68, v30, v31
  v_lshlrev_b32 v30, 16, v69
  v_and_b32 v31, 0xffff0000, v69
  v_pk_fma_f32 v[30:31], v[30:31], v[130:131], v[130:131] op_sel:[0,0,1] op_sel_hi:[1,0,1] neg_lo:[0,0,1] neg_hi:[0,0,1]
  v_cvt_pk_bf16_f32 v69, v30, v31
  v_lshlrev_b32 v30, 16, v70
  v_and_b32 v31, 0xffff0000, v70
  v_pk_fma_f32 v[30:31], v[30:31], v[130:131], v[130:131] op_sel:[0,0,1] op_sel_hi:[1,0,1] neg_lo:[0,0,1] neg_hi:[0,0,1]
  v_cvt_pk_bf16_f32 v70, v30, v31
  v_lshlrev_b32 v30, 16, v71
  v_and_b32 v31, 0xffff0000, v71
  v_pk_fma_f32 v[30:31], v[30:31], v[130:131], v[130:131] op_sel:[0,0,1] op_sel_hi:[1,0,1] neg_lo:[0,0,1] neg_hi:[0,0,1]
  v_cvt_pk_bf16_f32 v71, v30, v31
  s_mov_b32 s35, 7905280
  buffer_store_dwordx4 v[52:55], v26, s[16:19], s35 offen offset:0 sc1
  buffer_store_dwordx4 v[56:59], v26, s[16:19], s35 offen offset:256 sc1
  buffer_store_dwordx4 v[60:63], v26, s[16:19], s35 offen offset:512 sc1
  buffer_store_dwordx4 v[64:67], v26, s[16:19], s35 offen offset:768 sc1
  buffer_store_dwordx4 v[68:71], v26, s[16:19], s35 offen offset:1024 sc1
  v_lshlrev_b32 v30, 16, v72
  v_and_b32 v31, 0xffff0000, v72
  v_pk_fma_f32 v[30:31], v[30:31], v[132:133], v[132:133] op_sel:[0,0,1] op_sel_hi:[1,0,1] neg_lo:[0,0,1] neg_hi:[0,0,1]
  v_cvt_pk_bf16_f32 v72, v30, v31
  v_lshlrev_b32 v30, 16, v73
  v_and_b32 v31, 0xffff0000, v73
  v_pk_fma_f32 v[30:31], v[30:31], v[132:133], v[132:133] op_sel:[0,0,1] op_sel_hi:[1,0,1] neg_lo:[0,0,1] neg_hi:[0,0,1]
  v_cvt_pk_bf16_f32 v73, v30, v31
  v_lshlrev_b32 v30, 16, v74
  v_and_b32 v31, 0xffff0000, v74
  v_pk_fma_f32 v[30:31], v[30:31], v[132:133], v[132:133] op_sel:[0,0,1] op_sel_hi:[1,0,1] neg_lo:[0,0,1] neg_hi:[0,0,1]
  v_cvt_pk_bf16_f32 v74, v30, v31
  v_lshlrev_b32 v30, 16, v75
  v_and_b32 v31, 0xffff0000, v75
  v_pk_fma_f32 v[30:31], v[30:31], v[132:133], v[132:133] op_sel:[0,0,1] op_sel_hi:[1,0,1] neg_lo:[0,0,1] neg_hi:[0,0,1]
  v_cvt_pk_bf16_f32 v75, v30, v31
  v_lshlrev_b32 v30, 16, v76
  v_and_b32 v31, 0xffff0000, v76
  v_pk_fma_f32 v[30:31], v[30:31], v[132:133], v[132:133] op_sel:[0,0,1] op_sel_hi:[1,0,1] neg_lo:[0,0,1] neg_hi:[0,0,1]
  v_cvt_pk_bf16_f32 v76, v30, v31
  v_lshlrev_b32 v30, 16, v77
  v_and_b32 v31, 0xffff0000, v77
  v_pk_fma_f32 v[30:31], v[30:31], v[132:133], v[132:133] op_sel:[0,0,1] op_sel_hi:[1,0,1] neg_lo:[0,0,1] neg_hi:[0,0,1]
  v_cvt_pk_bf16_f32 v77, v30, v31
  v_lshlrev_b32 v30, 16, v78
  v_and_b32 v31, 0xffff0000, v78
  v_pk_fma_f32 v[30:31], v[30:31], v[132:133], v[132:133] op_sel:[0,0,1] op_sel_hi:[1,0,1] neg_lo:[0,0,1] neg_hi:[0,0,1]
  v_cvt_pk_bf16_f32 v78, v30, v31
  v_lshlrev_b32 v30, 16, v79
  v_and_b32 v31, 0xffff0000, v79
  v_pk_fma_f32 v[30:31], v[30:31], v[132:133], v[132:133] op_sel:[0,0,1] op_sel_hi:[1,0,1] neg_lo:[0,0,1] neg_hi:[0,0,1]
  v_cvt_pk_bf16_f32 v79, v30, v31
  v_lshlrev_b32 v30, 16, v80
  v_and_b32 v31, 0xffff0000, v80
  v_pk_fma_f32 v[30:31], v[30:31], v[132:133], v[132:133] op_sel:[0,0,1] op_sel_hi:[1,0,1] neg_lo:[0,0,1] neg_hi:[0,0,1]
  v_cvt_pk_bf16_f32 v80, v30, v31
  v_lshlrev_b32 v30, 16, v81
  v_and_b32 v31, 0xffff0000, v81
  v_pk_fma_f32 v[30:31], v[30:31], v[132:133], v[132:133] op_sel:[0,0,1] op_sel_hi:[1,0,1] neg_lo:[0,0,1] neg_hi:[0,0,1]
  v_cvt_pk_bf16_f32 v81, v30, v31
  v_lshlrev_b32 v30, 16, v82
  v_and_b32 v31, 0xffff0000, v82
  v_pk_fma_f32 v[30:31], v[30:31], v[132:133], v[132:133] op_sel:[0,0,1] op_sel_hi:[1,0,1] neg_lo:[0,0,1] neg_hi:[0,0,1]
  v_cvt_pk_bf16_f32 v82, v30, v31
  v_lshlrev_b32 v30, 16, v83
  v_and_b32 v31, 0xffff0000, v83
  v_pk_fma_f32 v[30:31], v[30:31], v[132:133], v[132:133] op_sel:[0,0,1] op_sel_hi:[1,0,1] neg_lo:[0,0,1] neg_hi:[0,0,1]
  v_cvt_pk_bf16_f32 v83, v30, v31
  v_lshlrev_b32 v30, 16, v84
  v_and_b32 v31, 0xffff0000, v84
  v_pk_fma_f32 v[30:31], v[30:31], v[132:133], v[132:133] op_sel:[0,0,1] op_sel_hi:[1,0,1] neg_lo:[0,0,1] neg_hi:[0,0,1]
  v_cvt_pk_bf16_f32 v84, v30, v31
  v_lshlrev_b32 v30, 16, v85
  v_and_b32 v31, 0xffff0000, v85
  v_pk_fma_f32 v[30:31], v[30:31], v[132:133], v[132:133] op_sel:[0,0,1] op_sel_hi:[1,0,1] neg_lo:[0,0,1] neg_hi:[0,0,1]
  v_cvt_pk_bf16_f32 v85, v30, v31
  v_lshlrev_b32 v30, 16, v86
  v_and_b32 v31, 0xffff0000, v86
  v_pk_fma_f32 v[30:31], v[30:31], v[132:133], v[132:133] op_sel:[0,0,1] op_sel_hi:[1,0,1] neg_lo:[0,0,1] neg_hi:[0,0,1]
  v_cvt_pk_bf16_f32 v86, v30, v31
  v_lshlrev_b32 v30, 16, v87
  v_and_b32 v31, 0xffff0000, v87
  v_pk_fma_f32 v[30:31], v[30:31], v[132:133], v[132:133] op_sel:[0,0,1] op_sel_hi:[1,0,1] neg_lo:[0,0,1] neg_hi:[0,0,1]
  v_cvt_pk_bf16_f32 v87, v30, v31
  v_lshlrev_b32 v30, 16, v88
  v_and_b32 v31, 0xffff0000, v88
  v_pk_fma_f32 v[30:31], v[30:31], v[132:133], v[132:133] op_sel:[0,0,1] op_sel_hi:[1,0,1] neg_lo:[0,0,1] neg_hi:[0,0,1]
  v_cvt_pk_bf16_f32 v88, v30, v31
  v_lshlrev_b32 v30, 16, v89
  v_and_b32 v31, 0xffff0000, v89
  v_pk_fma_f32 v[30:31], v[30:31], v[132:133], v[132:133] op_sel:[0,0,1] op_sel_hi:[1,0,1] neg_lo:[0,0,1] neg_hi:[0,0,1]
  v_cvt_pk_bf16_f32 v89, v30, v31
  v_lshlrev_b32 v30, 16, v90
  v_and_b32 v31, 0xffff0000, v90
  v_pk_fma_f32 v[30:31], v[30:31], v[132:133], v[132:133] op_sel:[0,0,1] op_sel_hi:[1,0,1] neg_lo:[0,0,1] neg_hi:[0,0,1]
  v_cvt_pk_bf16_f32 v90, v30, v31
  v_lshlrev_b32 v30, 16, v91
  v_and_b32 v31, 0xffff0000, v91
  v_pk_fma_f32 v[30:31], v[30:31], v[132:133], v[132:133] op_sel:[0,0,1] op_sel_hi:[1,0,1] neg_lo:[0,0,1] neg_hi:[0,0,1]
  v_cvt_pk_bf16_f32 v91, v30, v31
  s_mov_b32 s35, 7946240
  buffer_store_dwordx4 v[72:75], v26, s[16:19], s35 offen offset:0 sc1
  buffer_store_dwordx4 v[76:79], v26, s[16:19], s35 offen offset:256 sc1
  buffer_store_dwordx4 v[80:83], v26, s[16:19], s35 offen offset:512 sc1
  buffer_store_dwordx4 v[84:87], v26, s[16:19], s35 offen offset:768 sc1
  buffer_store_dwordx4 v[88:91], v26, s[16:19], s35 offen offset:1024 sc1
  v_lshlrev_b32 v30, 16, v92
  v_and_b32 v31, 0xffff0000, v92
  v_pk_fma_f32 v[30:31], v[30:31], v[134:135], v[134:135] op_sel:[0,0,1] op_sel_hi:[1,0,1] neg_lo:[0,0,1] neg_hi:[0,0,1]
  v_cvt_pk_bf16_f32 v92, v30, v31
  v_lshlrev_b32 v30, 16, v93
  v_and_b32 v31, 0xffff0000, v93
  v_pk_fma_f32 v[30:31], v[30:31], v[134:135], v[134:135] op_sel:[0,0,1] op_sel_hi:[1,0,1] neg_lo:[0,0,1] neg_hi:[0,0,1]
  v_cvt_pk_bf16_f32 v93, v30, v31
  v_lshlrev_b32 v30, 16, v94
  v_and_b32 v31, 0xffff0000, v94
  v_pk_fma_f32 v[30:31], v[30:31], v[134:135], v[134:135] op_sel:[0,0,1] op_sel_hi:[1,0,1] neg_lo:[0,0,1] neg_hi:[0,0,1]
  v_cvt_pk_bf16_f32 v94, v30, v31
  v_lshlrev_b32 v30, 16, v95
  v_and_b32 v31, 0xffff0000, v95
  v_pk_fma_f32 v[30:31], v[30:31], v[134:135], v[134:135] op_sel:[0,0,1] op_sel_hi:[1,0,1] neg_lo:[0,0,1] neg_hi:[0,0,1]
  v_cvt_pk_bf16_f32 v95, v30, v31
  v_lshlrev_b32 v30, 16, v96
  v_and_b32 v31, 0xffff0000, v96
  v_pk_fma_f32 v[30:31], v[30:31], v[134:135], v[134:135] op_sel:[0,0,1] op_sel_hi:[1,0,1] neg_lo:[0,0,1] neg_hi:[0,0,1]
  v_cvt_pk_bf16_f32 v96, v30, v31
  v_lshlrev_b32 v30, 16, v97
  v_and_b32 v31, 0xffff0000, v97
  v_pk_fma_f32 v[30:31], v[30:31], v[134:135], v[134:135] op_sel:[0,0,1] op_sel_hi:[1,0,1] neg_lo:[0,0,1] neg_hi:[0,0,1]
  v_cvt_pk_bf16_f32 v97, v30, v31
  v_lshlrev_b32 v30, 16, v98
  v_and_b32 v31, 0xffff0000, v98
  v_pk_fma_f32 v[30:31], v[30:31], v[134:135], v[134:135] op_sel:[0,0,1] op_sel_hi:[1,0,1] neg_lo:[0,0,1] neg_hi:[0,0,1]
  v_cvt_pk_bf16_f32 v98, v30, v31
  v_lshlrev_b32 v30, 16, v99
  v_and_b32 v31, 0xffff0000, v99
  v_pk_fma_f32 v[30:31], v[30:31], v[134:135], v[134:135] op_sel:[0,0,1] op_sel_hi:[1,0,1] neg_lo:[0,0,1] neg_hi:[0,0,1]
  v_cvt_pk_bf16_f32 v99, v30, v31
  v_lshlrev_b32 v30, 16, v100
  v_and_b32 v31, 0xffff0000, v100
  v_pk_fma_f32 v[30:31], v[30:31], v[134:135], v[134:135] op_sel:[0,0,1] op_sel_hi:[1,0,1] neg_lo:[0,0,1] neg_hi:[0,0,1]
  v_cvt_pk_bf16_f32 v100, v30, v31
  v_lshlrev_b32 v30, 16, v101
  v_and_b32 v31, 0xffff0000, v101
  v_pk_fma_f32 v[30:31], v[30:31], v[134:135], v[134:135] op_sel:[0,0,1] op_sel_hi:[1,0,1] neg_lo:[0,0,1] neg_hi:[0,0,1]
  v_cvt_pk_bf16_f32 v101, v30, v31
  v_lshlrev_b32 v30, 16, v102
  v_and_b32 v31, 0xffff0000, v102
  v_pk_fma_f32 v[30:31], v[30:31], v[134:135], v[134:135] op_sel:[0,0,1] op_sel_hi:[1,0,1] neg_lo:[0,0,1] neg_hi:[0,0,1]
  v_cvt_pk_bf16_f32 v102, v30, v31
  v_lshlrev_b32 v30, 16, v103
  v_and_b32 v31, 0xffff0000, v103
  v_pk_fma_f32 v[30:31], v[30:31], v[134:135], v[134:135] op_sel:[0,0,1] op_sel_hi:[1,0,1] neg_lo:[0,0,1] neg_hi:[0,0,1]
  v_cvt_pk_bf16_f32 v103, v30, v31
  v_lshlrev_b32 v30, 16, v104
  v_and_b32 v31, 0xffff0000, v104
  v_pk_fma_f32 v[30:31], v[30:31], v[134:135], v[134:135] op_sel:[0,0,1] op_sel_hi:[1,0,1] neg_lo:[0,0,1] neg_hi:[0,0,1]
  v_cvt_pk_bf16_f32 v104, v30, v31
  v_lshlrev_b32 v30, 16, v105
  v_and_b32 v31, 0xffff0000, v105
  v_pk_fma_f32 v[30:31], v[30:31], v[134:135], v[134:135] op_sel:[0,0,1] op_sel_hi:[1,0,1] neg_lo:[0,0,1] neg_hi:[0,0,1]
  v_cvt_pk_bf16_f32 v105, v30, v31
  v_lshlrev_b32 v30, 16, v106
  v_and_b32 v31, 0xffff0000, v106
  v_pk_fma_f32 v[30:31], v[30:31], v[134:135], v[134:135] op_sel:[0,0,1] op_sel_hi:[1,0,1] neg_lo:[0,0,1] neg_hi:[0,0,1]
  v_cvt_pk_bf16_f32 v106, v30, v31
  v_lshlrev_b32 v30, 16, v107
  v_and_b32 v31, 0xffff0000, v107
  v_pk_fma_f32 v[30:31], v[30:31], v[134:135], v[134:135] op_sel:[0,0,1] op_sel_hi:[1,0,1] neg_lo:[0,0,1] neg_hi:[0,0,1]
  v_cvt_pk_bf16_f32 v107, v30, v31
  v_lshlrev_b32 v30, 16, v108
  v_and_b32 v31, 0xffff0000, v108
  v_pk_fma_f32 v[30:31], v[30:31], v[134:135], v[134:135] op_sel:[0,0,1] op_sel_hi:[1,0,1] neg_lo:[0,0,1] neg_hi:[0,0,1]
  v_cvt_pk_bf16_f32 v108, v30, v31
  v_lshlrev_b32 v30, 16, v109
  v_and_b32 v31, 0xffff0000, v109
  v_pk_fma_f32 v[30:31], v[30:31], v[134:135], v[134:135] op_sel:[0,0,1] op_sel_hi:[1,0,1] neg_lo:[0,0,1] neg_hi:[0,0,1]
  v_cvt_pk_bf16_f32 v109, v30, v31
  v_lshlrev_b32 v30, 16, v110
  v_and_b32 v31, 0xffff0000, v110
  v_pk_fma_f32 v[30:31], v[30:31], v[134:135], v[134:135] op_sel:[0,0,1] op_sel_hi:[1,0,1] neg_lo:[0,0,1] neg_hi:[0,0,1]
  v_cvt_pk_bf16_f32 v110, v30, v31
  v_lshlrev_b32 v30, 16, v111
  v_and_b32 v31, 0xffff0000, v111
  v_pk_fma_f32 v[30:31], v[30:31], v[134:135], v[134:135] op_sel:[0,0,1] op_sel_hi:[1,0,1] neg_lo:[0,0,1] neg_hi:[0,0,1]
  v_cvt_pk_bf16_f32 v111, v30, v31
  s_mov_b32 s35, 7987200
  buffer_store_dwordx4 v[92:95], v26, s[16:19], s35 offen offset:0 sc1
  buffer_store_dwordx4 v[96:99], v26, s[16:19], s35 offen offset:256 sc1
  buffer_store_dwordx4 v[100:103], v26, s[16:19], s35 offen offset:512 sc1
  buffer_store_dwordx4 v[104:107], v26, s[16:19], s35 offen offset:768 sc1
  buffer_store_dwordx4 v[108:111], v26, s[16:19], s35 offen offset:1024 sc1
La_ln_end:
  s_cmp_eq_u32 s22, 4
  s_cbranch_scc0 La_ln_notag
  s_cmp_lg_u32 s101, 0
  s_cbranch_scc1 Lnonce_2_ok
  v_mov_b32 v30, 64
  s_mov_b32 s37, 0
Lnonce_2:
  buffer_load_dword v31, v30, s[44:47], 0 offen sc1
  s_waitcnt vmcnt(0)
  v_readfirstlane_b32 s101, v31
  s_add_u32 s37, s37, 1
  s_nop 2
  s_cmp_lg_u32 s101, 0
  s_cbranch_scc1 Lnonce_2_ok
  s_sleep 4
  s_cmp_lt_u32 s37, 200000
  s_cbranch_scc1 Lnonce_2
Lnonce_2_ok:
  v_mov_b32 v30, 155432
  v_mov_b32 v31, s101
  ds_write_b32 v30, v31
La_ln_notag:
  s_waitcnt lgkmcnt(0)
  s_waitcnt vmcnt(0)
  s_barrier
  s_cmp_eq_u32 s22, 0
  s_cbranch_scc0 La_done
  v_mov_b32 v30, 155432
  ds_read_b32 v31, v30
  s_waitcnt lgkmcnt(0)
  v_readfirstlane_b32 s101, v31
  s_nop 3
  s_mov_b32 s16, s20
  s_and_b32 s17, s21, 0xffff
  s_mov_b32 s18, 16388096
  s_mov_b32 s19, 0x20000
  s_and_b32 s33, s3, 0xff
  s_lshl_b32 s33, s33, 7
  s_add_u32 s33, s33, 16269312
  v_mov_b32 v30, s33
  v_mov_b32 v31, s101
  s_mov_b64 exec, 1
  buffer_store_dword v31, v30, s[16:19], 0 offen sc1
  s_mov_b64 exec, -1
  s_branch La_done
La_store_h:
  s_cmp_ge_u32 s26, 5
  s_cselect_b32 s44, 5, 0
  s_cselect_b32 s42, 2621440, 0
  s_sub_u32 s44, s26, s44
  s_lshl_b32 s36, s44, 5
  s_mul_i32 s44, s36, 205
  s_lshr_b32 s39, s44, 10
  s_mul_i32 s44, s39, 5
  s_sub_u32 s44, s36, s44
  s_sub_u32 s37, 5, s44
  s_cmp_eq_u32 s44, 0
  s_cselect_b32 s37, 0, s37
  s_mul_i32 s45, s39, 81920
  s_cmp_lg_u32 s37, 0
  s_addc_u32 s39, s39, 0
  s_sub_u32 s44, 32, s37
  s_mul_i32 s40, s44, 52
  s_lshr_b32 s40, s40, 8
  s_mul_i32 s41, s40, 5
  s_sub_u32 s41, s44, s41
  s_lshl_b32 s43, s25, 7
  s_mul_i32 s43, s43, 40
  s_add_u32 s42, s42, s43
  s_add_u32 s45, s45, s42
  s_mov_b32 s16, s20
  s_and_b32 s17, s21, 0xffff
  s_mov_b32 s18, 16269312
  s_mov_b32 s19, 0x20000
  v_lshlrev_b32 v24, 4, v1
  s_lshl_b32 s44, s37, 10
  s_add_u32 s44, s44, 98304
  v_add_u32 v25, s44, v24
  s_mul_i32 s38, s40, 5
  s_waitcnt lgkmcnt(0)
  s_barrier
  s_cmp_lt_u32 s22, 4
  s_cbranch_scc1 La_done
  s_sub_u32 s22, s22, 4
  s_add_u32 s44, s22, 0
  s_cmp_ge_u32 s44, s38
  s_cbranch_scc1 La_sh_full0
  s_lshl_b32 s46, s44, 10
  v_add_u32 v26, s46, v25
  ds_read_b128 v[128:131], v26
  s_mul_i32 s46, s44, 52
  s_lshr_b32 s46, s46, 8
  s_mul_i32 s47, s46, 5
  s_sub_u32 s44, s44, s47
  s_add_u32 s46, s46, s39
  s_mul_i32 s46, s46, 81920
  s_lshl_b32 s44, s44, 10
  s_add_u32 s46, s46, s44
  s_add_u32 s46, s46, s42
  s_waitcnt lgkmcnt(0)
  buffer_store_dwordx4 v[128:131], v24, s[16:19], s46 offen sc1
La_sh_full0:
  s_add_u32 s44, s22, 4
  s_cmp_ge_u32 s44, s38
  s_cbranch_scc1 La_sh_full1
  s_lshl_b32 s46, s44, 10
  v_add_u32 v26, s46, v25
  ds_read_b128 v[132:135], v26
  s_mul_i32 s46, s44, 52
  s_lshr_b32 s46, s46, 8
  s_mul_i32 s47, s46, 5
  s_sub_u32 s44, s44, s47
  s_add_u32 s46, s46, s39
  s_mul_i32 s46, s46, 81920
  s_lshl_b32 s44, s44, 10
  s_add_u32 s46, s46, s44
  s_add_u32 s46, s46, s42
  s_waitcnt lgkmcnt(0)
  buffer_store_dwordx4 v[132:135], v24, s[16:19], s46 offen sc1
La_sh_full1:
  s_add_u32 s44, s22, 8
  s_cmp_ge_u32 s44, s38
  s_cbranch_scc1 La_sh_full2
  s_lshl_b32 s46, s44, 10
  v_add_u32 v26, s46, v25
  ds_read_b128 v[136:139], v26
  s_mul_i32 s46, s44, 52
  s_lshr_b32 s46, s46, 8
  s_mul_i32 s47, s46, 5
  s_sub_u32 s44, s44, s47
  s_add_u32 s46, s46, s39
  s_mul_i32 s46, s46, 81920
  s_lshl_b32 s44, s44, 10
  s_add_u32 s46, s46, s44
  s_add_u32 s46, s46, s42
  s_waitcnt lgkmcnt(0)
  buffer_store_dwordx4 v[136:139], v24, s[16:19], s46 offen sc1
La_sh_full2:
  s_add_u32 s44, s22, 12
  s_cmp_ge_u32 s44, s38
  s_cbranch_scc1 La_sh_full3
  s_lshl_b32 s46, s44, 10
  v_add_u32 v26, s46, v25
  ds_read_b128 v[140:143], v26
  s_mul_i32 s46, s44, 52
  s_lshr_b32 s46, s46, 8
  s_mul_i32 s47, s46, 5
  s_sub_u32 s44, s44, s47
  s_add_u32 s46, s46, s39
  s_mul_i32 s46, s46, 81920
  s_lshl_b32 s44, s44, 10
  s_add_u32 s46, s46, s44
  s_add_u32 s46, s46, s42
  s_waitcnt lgkmcnt(0)
  buffer_store_dwordx4 v[140:143], v24, s[16:19], s46 offen sc1
La_sh_full3:
  s_add_u32 s44, s22, 16
  s_cmp_ge_u32 s44, s38
  s_cbranch_scc1 La_sh_full4
  s_lshl_b32 s46, s44, 10
  v_add_u32 v26, s46, v25
  ds_read_b128 v[144:147], v26
  s_mul_i32 s46, s44, 52
  s_lshr_b32 s46, s46, 8
  s_mul_i32 s47, s46, 5
  s_sub_u32 s44, s44, s47
  s_add_u32 s46, s46, s39
  s_mul_i32 s46, s46, 81920
  s_lshl_b32 s44, s44, 10
  s_add_u32 s46, s46, s44
  s_add_u32 s46, s46, s42
  s_waitcnt lgkmcnt(0)
  buffer_store_dwordx4 v[144:147], v24, s[16:19], s46 offen sc1
La_sh_full4:
  s_add_u32 s44, s22, 20
  s_cmp_ge_u32 s44, s38
  s_cbranch_scc1 La_sh_full5
  s_lshl_b32 s46, s44, 10
  v_add_u32 v26, s46, v25
  ds_read_b128 v[148:151], v26
  s_mul_i32 s46, s44, 52
  s_lshr_b32 s46, s46, 8
  s_mul_i32 s47, s46, 5
  s_sub_u32 s44, s44, s47
  s_add_u32 s46, s46, s39
  s_mul_i32 s46, s46, 81920
  s_lshl_b32 s44, s44, 10
  s_add_u32 s46, s46, s44
  s_add_u32 s46, s46, s42
  s_waitcnt lgkmcnt(0)
  buffer_store_dwordx4 v[148:151], v24, s[16:19], s46 offen sc1
La_sh_full5:
  s_add_u32 s44, s22, 24
  s_cmp_ge_u32 s44, s38
  s_cbranch_scc1 La_sh_full6
  s_lshl_b32 s46, s44, 10
  v_add_u32 v26, s46, v25
  ds_read_b128 v[152:155], v26
  s_mul_i32 s46, s44, 52
  s_lshr_b32 s46, s46, 8
  s_mul_i32 s47, s46, 5
  s_sub_u32 s44, s44, s47
  s_add_u32 s46, s46, s39
  s_mul_i32 s46, s46, 81920
  s_lshl_b32 s44, s44, 10
  s_add_u32 s46, s46, s44
  s_add_u32 s46, s46, s42
  s_waitcnt lgkmcnt(0)
  buffer_store_dwordx4 v[152:155], v24, s[16:19], s46 offen sc1
La_sh_full6:
  s_add_u32 s44, s22, 28
  s_cmp_ge_u32 s44, s38
  s_cbranch_scc1 La_sh_full7
  s_lshl_b32 s46, s44, 10
  v_add_u32 v26, s46, v25
  ds_read_b128 v[156:159], v26
  s_mul_i32 s46, s44, 52
  s_lshr_b32 s46, s46, 8
  s_mul_i32 s47, s46, 5
  s_sub_u32 s44, s44, s47
  s_add_u32 s46, s46, s39
  s_mul_i32 s46, s46, 81920
  s_lshl_b32 s44, s44, 10
  s_add_u32 s46, s46, s44
  s_add_u32 s46, s46, s42
  s_waitcnt lgkmcnt(0)
  buffer_store_dwordx4 v[156:159], v24, s[16:19], s46 offen sc1
La_sh_full7:
  s_add_u32 s44, s22, 0
  s_lshl_b32 s46, s37, 1
  s_cmp_lt_u32 s44, s46
  s_cbranch_scc1 La_sh_part0_lead
  s_sub_u32 s44, s44, s46
  s_lshl_b32 s46, s41, 1
  s_cmp_ge_u32 s44, s46
  s_cbranch_scc1 La_sh_part0
  s_mov_b32 s47, s41
  s_add_u32 s48, s37, s38
  s_lshl_b32 s48, s48, 10
  s_add_u32 s49, s39, s40
  s_mul_i32 s49, s49, 81920
  s_add_u32 s49, s49, s42
  s_branch La_sh_part0_go
La_sh_part0_lead:
  s_mov_b32 s47, s37
  s_mov_b32 s48, 0
  s_sub_u32 s49, 5, s37
  s_lshl_b32 s49, s49, 3
  s_add_u32 s49, s49, s45
La_sh_part0_go:
  s_lshl_b32 s44, s44, 6
  v_add_u32 v26, s44, v1
  v_lshlrev_b32 v27, 3, v26
  s_add_u32 s48, s48, 98304
  v_add_u32 v27, s48, v27
  ds_read_b64 v[160:161], v27
  s_mov_b32 s46, 0x10000
  s_cmp_eq_u32 s47, 2
  s_cselect_b32 s46, 0x8000, s46
  s_cmp_eq_u32 s47, 3
  s_cselect_b32 s46, 21846, s46
  s_cmp_eq_u32 s47, 4
  s_cselect_b32 s46, 0x4000, s46
  v_mul_u32_u24 v28, s46, v26
  v_lshrrev_b32 v28, 16, v28
  v_mul_u32_u24 v29, s47, v28
  v_sub_u32 v29, v26, v29
  v_mul_u32_u24 v28, 40, v28
  v_lshl_add_u32 v28, v29, 3, v28
  s_waitcnt lgkmcnt(0)
  buffer_store_dwordx2 v[160:161], v28, s[16:19], s49 offen sc1
La_sh_part0:
  s_add_u32 s44, s22, 4
  s_lshl_b32 s46, s37, 1
  s_cmp_lt_u32 s44, s46
  s_cbranch_scc1 La_sh_part1_lead
  s_sub_u32 s44, s44, s46
  s_lshl_b32 s46, s41, 1
  s_cmp_ge_u32 s44, s46
  s_cbranch_scc1 La_sh_part1
  s_mov_b32 s47, s41
  s_add_u32 s48, s37, s38
  s_lshl_b32 s48, s48, 10
  s_add_u32 s49, s39, s40
  s_mul_i32 s49, s49, 81920
  s_add_u32 s49, s49, s42
  s_branch La_sh_part1_go
La_sh_part1_lead:
  s_mov_b32 s47, s37
  s_mov_b32 s48, 0
  s_sub_u32 s49, 5, s37
  s_lshl_b32 s49, s49, 3
  s_add_u32 s49, s49, s45
La_sh_part1_go:
  s_lshl_b32 s44, s44, 6
  v_add_u32 v26, s44, v1
  v_lshlrev_b32 v27, 3, v26
  s_add_u32 s48, s48, 98304
  v_add_u32 v27, s48, v27
  ds_read_b64 v[162:163], v27
  s_mov_b32 s46, 0x10000
  s_cmp_eq_u32 s47, 2
  s_cselect_b32 s46, 0x8000, s46
  s_cmp_eq_u32 s47, 3
  s_cselect_b32 s46, 21846, s46
  s_cmp_eq_u32 s47, 4
  s_cselect_b32 s46, 0x4000, s46
  v_mul_u32_u24 v28, s46, v26
  v_lshrrev_b32 v28, 16, v28
  v_mul_u32_u24 v29, s47, v28
  v_sub_u32 v29, v26, v29
  v_mul_u32_u24 v28, 40, v28
  v_lshl_add_u32 v28, v29, 3, v28
  s_waitcnt lgkmcnt(0)
  buffer_store_dwordx2 v[162:163], v28, s[16:19], s49 offen sc1
La_sh_part1:
  s_add_u32 s44, s22, 8
  s_lshl_b32 s46, s37, 1
  s_cmp_lt_u32 s44, s46
  s_cbranch_scc1 La_sh_part2_lead
  s_sub_u32 s44, s44, s46
  s_lshl_b32 s46, s41, 1
  s_cmp_ge_u32 s44, s46
  s_cbranch_scc1 La_sh_part2
  s_mov_b32 s47, s41
  s_add_u32 s48, s37, s38
  s_lshl_b32 s48, s48, 10
  s_add_u32 s49, s39, s40
  s_mul_i32 s49, s49, 81920
  s_add_u32 s49, s49, s42
  s_branch La_sh_part2_go
La_sh_part2_lead:
  s_mov_b32 s47, s37
  s_mov_b32 s48, 0
  s_sub_u32 s49, 5, s37
  s_lshl_b32 s49, s49, 3
  s_add_u32 s49, s49, s45
La_sh_part2_go:
  s_lshl_b32 s44, s44, 6
  v_add_u32 v26, s44, v1
  v_lshlrev_b32 v27, 3, v26
  s_add_u32 s48, s48, 98304
  v_add_u32 v27, s48, v27
  ds_read_b64 v[164:165], v27
  s_mov_b32 s46, 0x10000
  s_cmp_eq_u32 s47, 2
  s_cselect_b32 s46, 0x8000, s46
  s_cmp_eq_u32 s47, 3
  s_cselect_b32 s46, 21846, s46
  s_cmp_eq_u32 s47, 4
  s_cselect_b32 s46, 0x4000, s46
  v_mul_u32_u24 v28, s46, v26
  v_lshrrev_b32 v28, 16, v28
  v_mul_u32_u24 v29, s47, v28
  v_sub_u32 v29, v26, v29
  v_mul_u32_u24 v28, 40, v28
  v_lshl_add_u32 v28, v29, 3, v28
  s_waitcnt lgkmcnt(0)
  buffer_store_dwordx2 v[164:165], v28, s[16:19], s49 offen sc1
La_sh_part2:
  s_add_u32 s44, s22, 12
  s_lshl_b32 s46, s37, 1
  s_cmp_lt_u32 s44, s46
  s_cbranch_scc1 La_sh_part3_lead
  s_sub_u32 s44, s44, s46
  s_lshl_b32 s46, s41, 1
  s_cmp_ge_u32 s44, s46
  s_cbranch_scc1 La_sh_part3
  s_mov_b32 s47, s41
  s_add_u32 s48, s37, s38
  s_lshl_b32 s48, s48, 10
  s_add_u32 s49, s39, s40
  s_mul_i32 s49, s49, 81920
  s_add_u32 s49, s49, s42
  s_branch La_sh_part3_go
La_sh_part3_lead:
  s_mov_b32 s47, s37
  s_mov_b32 s48, 0
  s_sub_u32 s49, 5, s37
  s_lshl_b32 s49, s49, 3
  s_add_u32 s49, s49, s45
La_sh_part3_go:
  s_lshl_b32 s44, s44, 6
  v_add_u32 v26, s44, v1
  v_lshlrev_b32 v27, 3, v26
  s_add_u32 s48, s48, 98304
  v_add_u32 v27, s48, v27
  ds_read_b64 v[166:167], v27
  s_mov_b32 s46, 0x10000
  s_cmp_eq_u32 s47, 2
  s_cselect_b32 s46, 0x8000, s46
  s_cmp_eq_u32 s47, 3
  s_cselect_b32 s46, 21846, s46
  s_cmp_eq_u32 s47, 4
  s_cselect_b32 s46, 0x4000, s46
  v_mul_u32_u24 v28, s46, v26
  v_lshrrev_b32 v28, 16, v28
  v_mul_u32_u24 v29, s47, v28
  v_sub_u32 v29, v26, v29
  v_mul_u32_u24 v28, 40, v28
  v_lshl_add_u32 v28, v29, 3, v28
  s_waitcnt lgkmcnt(0)
  buffer_store_dwordx2 v[166:167], v28, s[16:19], s49 offen sc1
La_sh_part3:
  s_branch La_done
La_store:
  s_cmp_ge_u32 s22, 4
  s_cbranch_scc0 La_noprio
  s_setprio 3
La_noprio:
  s_cmp_lt_u32 s26, 10
  s_cbranch_scc1 La_store_h
  s_and_b32 s39, s22, 3
  v_lshrrev_b32 v24, 4, v1
  s_mul_i32 s33, s39, 32
  v_add_u32 v24, s33, v24
  v_and_b32 v25, 15, v1
  v_mul_u32_u24 v26, 272, v24
  v_lshl_add_u32 v26, v25, 4, v26
  v_add_u32 v26, 98304, v26
  s_lshl_b32 s35, s25, 7
  s_sub_u32 s37, s26, 10
  s_lshl_b32 s37, s37, 19
  s_lshl_b32 s38, s35, 1
  s_add_u32 s37, s37, s38
  s_add_u32 s36, s37, 5242880
  v_lshlrev_b32 v27, 12, v24
  v_lshl_add_u32 v27, v25, 4, v27
  s_mov_b32 s16, s20
  s_and_b32 s17, s21, 0xffff
  s_mov_b32 s18, 16269312
  s_mov_b32 s19, 0x20000
  s_waitcnt lgkmcnt(0)
  s_barrier
  s_cmp_lt_u32 s22, 4
  s_cbranch_scc1 La_done
  ds_read_b128 v[128:131], v26 offset:0
  ds_read_b128 v[132:135], v26 offset:1088
  ds_read_b128 v[136:139], v26 offset:2176
  ds_read_b128 v[140:143], v26 offset:3264
  ds_read_b128 v[144:147], v26 offset:4352
  ds_read_b128 v[148:151], v26 offset:5440
  ds_read_b128 v[152:155], v26 offset:6528
  ds_read_b128 v[156:159], v26 offset:7616
  s_waitcnt lgkmcnt(7)
  buffer_store_dwordx4 v[128:131], v27, s[16:19], s36 offen sc1
  s_add_u32 s36, s36, 16384
  s_waitcnt lgkmcnt(6)
  buffer_store_dwordx4 v[132:135], v27, s[16:19], s36 offen sc1
  s_add_u32 s36, s36, 16384
  s_waitcnt lgkmcnt(5)
  buffer_store_dwordx4 v[136:139], v27, s[16:19], s36 offen sc1
  s_add_u32 s36, s36, 16384
  s_waitcnt lgkmcnt(4)
  buffer_store_dwordx4 v[140:143], v27, s[16:19], s36 offen sc1
  s_add_u32 s36, s36, 16384
  s_waitcnt lgkmcnt(3)
  buffer_store_dwordx4 v[144:147], v27, s[16:19], s36 offen sc1
  s_add_u32 s36, s36, 16384
  s_waitcnt lgkmcnt(2)
  buffer_store_dwordx4 v[148:151], v27, s[16:19], s36 offen sc1
  s_add_u32 s36, s36, 16384
  s_waitcnt lgkmcnt(1)
  buffer_store_dwordx4 v[152:155], v27, s[16:19], s36 offen sc1
  s_add_u32 s36, s36, 16384
  s_waitcnt lgkmcnt(0)
  buffer_store_dwordx4 v[156:159], v27, s[16:19], s36 offen sc1
  s_add_u32 s36, s36, 16384
La_done:
  s_load_dwordx4 s[4:7], s[0:1], 32
  s_load_dwordx2 s[20:21], s[0:1], 80
  s_load_dwordx2 s[34:35], s[0:1], 48
  v_and_b32 v1, 63, v0
  v_lshrrev_b32 v2, 6, v0
  s_nop 0
  v_readfirstlane_b32 s22, v2
  s_nop 3
  s_cmp_ge_u32 s22, 4
  s_cbranch_scc1 Lb_att
Lb_tm:
  s_setprio 1
  s_lshr_b32 s24, s2, 3
  s_cmp_ge_u32 s24, 30
  s_cbranch_scc1 Lb_wo
  s_and_b32 s25, s2, 7
  s_mul_i32 s26, s24, 52
  s_lshr_b32 s26, s26, 8
  s_mul_i32 s27, s26, 5
  s_sub_u32 s27, s24, s27
  s_and_b32 s28, s25, 1
  s_mul_i32 s28, s28, 5
  s_add_u32 s28, s28, s27
  s_lshr_b32 s29, s25, 1
  s_mul_i32 s29, s29, 6
  s_add_u32 s29, s29, s26
  s_lshl_b32 s42, s28, 6
  s_lshl_b32 s43, s29, 6
  v_lshrrev_b32 v14, 3, v1
  s_lshl_b32 s24, s22, 9
  v_add_u32 v14, s24, v14
  v_bfe_u32 v15, v1, 4, 1
  v_lshlrev_b32 v15, 2, v15
  v_and_b32 v16, 7, v1
  v_xor_b32 v15, v15, v16
  v_lshlrev_b32 v15, 4, v15
  v_mul_u32_u24 v16, 1280, v14
  v_add_u32 v16, v16, v15
  s_lshl_b32 s24, s42, 1
  v_add_u32 v2, s24, v16
  v_add_u32 v3, 9216, v2
  v_mul_u32_u24 v16, 3072, v14
  v_add_u32 v16, v16, v15
  s_lshl_b32 s24, s43, 1
  v_add_u32 v4, s24, v16
  v_add_u32 v5, 23552, v4
  s_mul_i32 s40, s22, 24576
  s_waitcnt lgkmcnt(0)
  v_mov_b32 v18, 155432
  ds_read_b32 v19, v18
  s_waitcnt lgkmcnt(0)
  v_readfirstlane_b32 s101, v19
  s_nop 3
  s_mov_b32 s64, s20
  s_and_b32 s65, s21, 0xffff
  s_mov_b32 s66, 16388096
  s_mov_b32 s67, 0x20000
  s_mov_b64 s[46:47], 0xffff
  s_waitcnt vmcnt(0)
  s_cmp_eq_u32 s22, 0
  s_cbranch_scc0 Lb_tm_hwait
  v_lshlrev_b32 v18, 11, v1
  v_add_u32 v18, 16271232, v18
  s_mov_b32 s30, 0
  v_mov_b32 v19, v216
  s_branch Lpt_3_chk
Lpt_3:
  s_mov_b64 exec, s[46:47]
  buffer_load_dword v19, v18, s[64:67], 0 offen sc1
  s_mov_b64 exec, -1
  s_waitcnt vmcnt(0)
Lpt_3_chk:
  v_cmp_ne_u32 vcc, s101, v19
  s_nop 4
  s_and_b64 vcc, vcc, s[46:47]
  s_cmp_eq_u64 vcc, 0
  s_cbranch_scc1 Lpt_3_ok
  s_add_u32 s30, s30, 1
  s_sleep 6
  s_cmp_lt_u32 s30, 200000
  s_cbranch_scc1 Lpt_3
Lpt_3_ok:
  v_mov_b32 v18, 155416
  v_mov_b32 v19, 1
  ds_write_b32 v18, v19
  s_branch Lb_tm_hok
Lb_tm_hwait:
  v_cmp_ne_u32 vcc, s101, v216
  s_nop 4
  s_and_b32 vcc_lo, vcc_lo, 0xffff
  s_cmp_eq_u32 vcc_lo, 0
  s_cbranch_scc1 Lb_tm_hok
  v_mov_b32 v18, 155416
  s_mov_b32 s31, 0
Lgo_4:
  ds_read_b32 v19, v18
  s_waitcnt lgkmcnt(0)
  v_readfirstlane_b32 s30, v19
  s_add_u32 s31, s31, 1
  s_nop 2
  s_cmp_lg_u32 s30, 0
  s_cbranch_scc1 Lgo_4_ok
  s_sleep 2
  s_cmp_lt_u32 s31, 0x400000
  s_cbranch_scc1 Lgo_4
Lgo_4_ok:
Lb_tm_hok:
  s_add_u32 s8, s20, 7864320
  s_addc_u32 s9, s21, 0
  s_and_b32 s9, s9, 0xffff
  s_mov_b32 s10, 2621440
  s_mov_b32 s11, 0x20000
  s_sub_u32 s12, s4, 2048
  s_subb_u32 s13, s5, 0
  s_and_b32 s13, s13, 0xffff
  s_mov_b32 s14, 6293504
  s_mov_b32 s15, 0x20000
  s_mov_b32 s44, 0
  s_mov_b32 s48, s6
  s_and_b32 s49, s7, 0xffff
  s_mov_b32 s50, 3072
  s_mov_b32 s51, 0x20000
  v_and_b32 v14, 31, v1
  s_and_b32 s24, s22, 1
  s_lshl_b32 s24, s24, 5
  s_add_u32 s24, s24, s43
  v_add_lshl_u32 v15, v14, s24, 1
  buffer_load_ushort v144, v15, s[48:51], 0 offen
  s_add_u32 m0, s40, 0
  s_mul_i32 s36, s44, 20480
  s_mul_i32 s37, s44, 49152
  buffer_load_dwordx4 v2, s[8:11], s36 offen sc1 lds
  buffer_load_dwordx4 v3, s[8:11], s36 offen offset:1024 sc1 lds
  buffer_load_dwordx4 v4, s[12:15], s37 offen offset:2048 lds
  buffer_load_dwordx4 v5, s[12:15], s37 offen offset:3072 lds
  s_add_u32 s44, s44, 1
  s_and_b32 s44, s44, 31
  s_add_u32 m0, s40, 4096
  s_mul_i32 s36, s44, 20480
  s_mul_i32 s37, s44, 49152
  buffer_load_dwordx4 v2, s[8:11], s36 offen sc1 lds
  buffer_load_dwordx4 v3, s[8:11], s36 offen offset:1024 sc1 lds
  buffer_load_dwordx4 v4, s[12:15], s37 offen offset:2048 lds
  buffer_load_dwordx4 v5, s[12:15], s37 offen offset:3072 lds
  s_add_u32 s44, s44, 1
  s_and_b32 s44, s44, 31
  s_add_u32 m0, s40, 8192
  s_mul_i32 s36, s44, 20480
  s_mul_i32 s37, s44, 49152
  buffer_load_dwordx4 v2, s[8:11], s36 offen sc1 lds
  buffer_load_dwordx4 v3, s[8:11], s36 offen offset:1024 sc1 lds
  buffer_load_dwordx4 v4, s[12:15], s37 offen offset:2048 lds
  buffer_load_dwordx4 v5, s[12:15], s37 offen offset:3072 lds
  s_add_u32 s44, s44, 1
  s_and_b32 s44, s44, 31
  s_add_u32 m0, s40, 12288
  s_mul_i32 s36, s44, 20480
  s_mul_i32 s37, s44, 49152
  buffer_load_dwordx4 v2, s[8:11], s36 offen sc1 lds
  buffer_load_dwordx4 v3, s[8:11], s36 offen offset:1024 sc1 lds
  buffer_load_dwordx4 v4, s[12:15], s37 offen offset:2048 lds
  buffer_load_dwordx4 v5, s[12:15], s37 offen offset:3072 lds
  s_add_u32 s44, s44, 1
  s_and_b32 s44, s44, 31
  s_lshr_b32 s52, s2, 3
  s_mul_i32 s53, s52, 48
  v_lshrrev_b32 v224, 2, v1
  v_add_u32 v224, s53, v224
  v_lshlrev_b32 v224, 12, v224
  v_and_b32 v225, 3, v1
  v_lshl_add_u32 v224, v225, 7, v224
  s_and_b32 s53, s2, 7
  s_lshl_b32 s53, s53, 9
  s_mov_b32 s56, s34
  s_and_b32 s57, s35, 0xffff
  s_mov_b32 s58, 6291456
  s_mov_b32 s59, 0x20000
  s_mul_i32 s55, s52, 43
  s_lshr_b32 s55, s55, 9
  s_mul_i32 s55, s55, 12
  s_sub_u32 s54, s52, s55
  s_add_u32 s54, s54, 2
  s_lshl_b32 s54, s54, 1
  s_cmp_eq_u32 s22, 0
  s_cselect_b32 s54, s54, 99
  s_mov_b32 s16, s20
  s_and_b32 s17, s21, 0xffff
  s_mov_b32 s18, 16252928
  s_mov_b32 s19, 0x20000
  v_bfe_u32 v14, v1, 2, 2
  v_lshrrev_b32 v15, 5, v1
  v_lshl_add_u32 v15, v15, 3, v14
  v_lshlrev_b32 v15, 7, v15
  v_and_b32 v16, 3, v1
  v_lshl_add_u32 v15, v16, 3, v15
  v_bfe_u32 v16, v1, 4, 1
  v_lshl_add_u32 v15, v16, 5, v15
  v_lshrrev_b32 v14, 1, v14
  v_lshl_add_u32 v15, v14, 6, v15
  s_lshr_b32 s24, s22, 1
  s_lshl_b32 s24, s24, 6
  v_xor_b32 v16, s24, v15
  v_add_u32 v6, s40, v16
  v_xor_b32 v16, 64, v16
  v_add_u32 v7, s40, v16
  s_and_b32 s24, s22, 1
  s_lshl_b32 s24, s24, 6
  v_xor_b32 v16, s24, v15
  v_add_u32 v16, 2048, v16
  v_add_u32 v8, s40, v16
  v_xor_b32 v16, 64, v16
  v_add_u32 v9, s40, v16
  v_mov_b32 v10, v6
  v_mov_b32 v11, v7
  v_mov_b32 v12, v8
  v_mov_b32 v13, v9
  v_mov_b32 v64, 0
  v_mov_b32 v65, 0
  v_mov_b32 v66, 0
  v_mov_b32 v67, 0
  v_mov_b32 v68, 0
  v_mov_b32 v69, 0
  v_mov_b32 v70, 0
  v_mov_b32 v71, 0
  v_mov_b32 v72, 0
  v_mov_b32 v73, 0
  v_mov_b32 v74, 0
  v_mov_b32 v75, 0
  v_mov_b32 v76, 0
  v_mov_b32 v77, 0
  v_mov_b32 v78, 0
  v_mov_b32 v79, 0
  v_mov_b32 v80, 0
  v_mov_b32 v81, 0
  v_mov_b32 v82, 0
  v_mov_b32 v83, 0
  v_mov_b32 v84, 0
  v_mov_b32 v85, 0
  v_mov_b32 v86, 0
  v_mov_b32 v87, 0
  v_mov_b32 v88, 0
  v_mov_b32 v89, 0
  v_mov_b32 v90, 0
  v_mov_b32 v91, 0
  v_mov_b32 v92, 0
  v_mov_b32 v93, 0
  v_mov_b32 v94, 0
  v_mov_b32 v95, 0
  v_mov_b32 v96, 0
  v_mov_b32 v97, 0
  v_mov_b32 v98, 0
  v_mov_b32 v99, 0
  v_mov_b32 v100, 0
  v_mov_b32 v101, 0
  v_mov_b32 v102, 0
  v_mov_b32 v103, 0
  v_mov_b32 v104, 0
  v_mov_b32 v105, 0
  v_mov_b32 v106, 0
  v_mov_b32 v107, 0
  v_mov_b32 v108, 0
  v_mov_b32 v109, 0
  v_mov_b32 v110, 0
  v_mov_b32 v111, 0
  v_mov_b32 v112, 0
  v_mov_b32 v113, 0
  v_mov_b32 v114, 0
  v_mov_b32 v115, 0
  v_mov_b32 v116, 0
  v_mov_b32 v117, 0
  v_mov_b32 v118, 0
  v_mov_b32 v119, 0
  v_mov_b32 v120, 0
  v_mov_b32 v121, 0
  v_mov_b32 v122, 0
  v_mov_b32 v123, 0
  v_mov_b32 v124, 0
  v_mov_b32 v125, 0
  v_mov_b32 v126, 0
  v_mov_b32 v127, 0
  s_mov_b32 s38, 0
  s_mov_b32 s39, 4096
  s_mov_b32 s41, 0
  s_mov_b32 s45, 16384
  s_waitcnt vmcnt(12)
  ds_read_b64_tr_b16 v[32:33], v10 offset:0
  ds_read_b64_tr_b16 v[34:35], v10 offset:512
  ds_read_b64_tr_b16 v[36:37], v11 offset:0
  ds_read_b64_tr_b16 v[38:39], v11 offset:512
  ds_read_b64_tr_b16 v[40:41], v12 offset:0
  ds_read_b64_tr_b16 v[42:43], v12 offset:512
  ds_read_b64_tr_b16 v[44:45], v13 offset:0
  ds_read_b64_tr_b16 v[46:47], v13 offset:512
Lb_tm_loop:
  v_add_u32 v10, s39, v6
  v_add_u32 v11, s39, v7
  v_add_u32 v12, s39, v8
  v_add_u32 v13, s39, v9
  s_add_u32 s24, s45, s40
  s_add_u32 s45, s45, 4096
  s_cmp_eq_u32 s45, 24576
  s_cselect_b32 s45, 0, s45
  s_mov_b32 m0, s24
  s_waitcnt vmcnt(8) lgkmcnt(0)
  v_mfma_f32_32x32x16_bf16 v[64:79], v[32:35], v[40:43], v[64:79]
  ds_read_b64_tr_b16 v[48:49], v10 offset:0
  ds_read_b64_tr_b16 v[50:51], v10 offset:512
  ds_read_b64_tr_b16 v[52:53], v11 offset:0
  ds_read_b64_tr_b16 v[54:55], v11 offset:512
  v_mfma_f32_32x32x16_bf16 v[80:95], v[32:35], v[44:47], v[80:95]
  ds_read_b64_tr_b16 v[56:57], v12 offset:0
  ds_read_b64_tr_b16 v[58:59], v12 offset:512
  ds_read_b64_tr_b16 v[60:61], v13 offset:0
  ds_read_b64_tr_b16 v[62:63], v13 offset:512
  v_mfma_f32_32x32x16_bf16 v[96:111], v[36:39], v[40:43], v[96:111]
  s_mul_i32 s36, s44, 20480
  s_mul_i32 s37, s44, 49152
  s_add_u32 s25, s41, 4
  s_cmp_lt_u32 s25, 32
  s_cselect_b32 s36, s36, 0x7000000
  s_cselect_b32 s37, s37, 0x7000000
  buffer_load_dwordx4 v2, s[8:11], s36 offen sc1 lds
  buffer_load_dwordx4 v3, s[8:11], s36 offen offset:1024 sc1 lds
  buffer_load_dwordx4 v4, s[12:15], s37 offen offset:2048 lds
  buffer_load_dwordx4 v5, s[12:15], s37 offen offset:3072 lds
  v_mfma_f32_32x32x16_bf16 v[112:127], v[36:39], v[44:47], v[112:127]
  s_add_u32 s44, s44, 1
  s_and_b32 s44, s44, 31
  s_add_u32 s39, s39, 4096
  s_cmp_eq_u32 s39, 24576
  s_cselect_b32 s39, 0, s39
  v_add_u32 v10, s39, v6
  v_add_u32 v11, s39, v7
  v_add_u32 v12, s39, v8
  v_add_u32 v13, s39, v9
  s_add_u32 s24, s45, s40
  s_add_u32 s45, s45, 4096
  s_cmp_eq_u32 s45, 24576
  s_cselect_b32 s45, 0, s45
  s_mov_b32 m0, s24
  s_waitcnt vmcnt(8) lgkmcnt(0)
  v_mfma_f32_32x32x16_bf16 v[64:79], v[48:51], v[56:59], v[64:79]
  ds_read_b64_tr_b16 v[32:33], v10 offset:0
  ds_read_b64_tr_b16 v[34:35], v10 offset:512
  ds_read_b64_tr_b16 v[36:37], v11 offset:0
  ds_read_b64_tr_b16 v[38:39], v11 offset:512
  v_mfma_f32_32x32x16_bf16 v[80:95], v[48:51], v[60:63], v[80:95]
  ds_read_b64_tr_b16 v[40:41], v12 offset:0
  ds_read_b64_tr_b16 v[42:43], v12 offset:512
  ds_read_b64_tr_b16 v[44:45], v13 offset:0
  ds_read_b64_tr_b16 v[46:47], v13 offset:512
  v_mfma_f32_32x32x16_bf16 v[96:111], v[52:55], v[56:59], v[96:111]
  s_mul_i32 s36, s44, 20480
  s_mul_i32 s37, s44, 49152
  s_add_u32 s25, s41, 5
  s_cmp_lt_u32 s25, 32
  s_cselect_b32 s36, s36, 0x7000000
  s_cselect_b32 s37, s37, 0x7000000
  buffer_load_dwordx4 v2, s[8:11], s36 offen sc1 lds
  buffer_load_dwordx4 v3, s[8:11], s36 offen offset:1024 sc1 lds
  buffer_load_dwordx4 v4, s[12:15], s37 offen offset:2048 lds
  buffer_load_dwordx4 v5, s[12:15], s37 offen offset:3072 lds
  v_mfma_f32_32x32x16_bf16 v[112:127], v[52:55], v[60:63], v[112:127]
  s_add_u32 s44, s44, 1
  s_and_b32 s44, s44, 31
  s_add_u32 s39, s39, 4096
  s_cmp_eq_u32 s39, 24576
  s_cselect_b32 s39, 0, s39
  s_add_u32 s41, s41, 2
  s_cmp_lt_u32 s41, 32
  s_cbranch_scc1 Lb_tm_loop
  s_setprio 3
  v_and_b32 v14, 31, v1
  s_and_b32 s24, s22, 1
  s_lshl_b32 s24, s24, 5
  s_waitcnt vmcnt(0) lgkmcnt(0)
  s_cmp_eq_u32 s22, 0
  s_cbranch_scc0 Lb_nopf4
  buffer_load_dword v240, v224, s[56:59], s53 offen
  s_add_u32 s53, s53, 65536
  buffer_load_dword v241, v224, s[56:59], s53 offen
  s_add_u32 s53, s53, 65536
  buffer_load_dword v242, v224, s[56:59], s53 offen
  s_add_u32 s53, s53, 65536
Lb_nopf4:
  v_lshlrev_b32 v16, 4, v1
  v_add_u32 v17, s40, v16
  s_nop 4
  ds_write_b128 v17, v[80:83] offset:0
  ds_write_b128 v17, v[84:87] offset:1024
  ds_write_b128 v17, v[88:91] offset:2048
  ds_write_b128 v17, v[92:95] offset:3072
  ds_write_b128 v17, v[96:99] offset:4096
  ds_write_b128 v17, v[100:103] offset:5120
  ds_write_b128 v17, v[104:107] offset:6144
  ds_write_b128 v17, v[108:111] offset:7168
  ds_write_b128 v17, v[112:115] offset:8192
  ds_write_b128 v17, v[116:119] offset:9216
  ds_write_b128 v17, v[120:123] offset:10240
  ds_write_b128 v17, v[124:127] offset:11264
  v_mov_b32 v18, 155400
  v_mov_b32 v19, 1
  s_waitcnt lgkmcnt(0)
  s_mov_b64 exec, 1
  ds_add_u32 v18, v19
  s_mov_b64 exec, -1
  s_mov_b32 s28, 0
Lb_sync_5:
  ds_read_b32 v19, v18
  s_waitcnt lgkmcnt(0)
  v_readfirstlane_b32 s27, v19
  s_add_u32 s28, s28, 1
  s_nop 2
  s_cmp_ge_u32 s27, 4
  s_cbranch_scc1 Lb_sync_5_done
  s_sleep 1
  s_cmp_lt_u32 s28, 0x400000
  s_cbranch_scc1 Lb_sync_5
Lb_sync_5_done:
  s_xor_b32 s25, s22, 1
  s_mul_i32 s25, s25, 24576
  v_add_u32 v17, s25, v16
  ds_read_b128 v[80:83], v17 offset:0
  ds_read_b128 v[84:87], v17 offset:1024
  ds_read_b128 v[88:91], v17 offset:2048
  ds_read_b128 v[92:95], v17 offset:3072
  s_xor_b32 s25, s22, 2
  s_mul_i32 s25, s25, 24576
  v_add_u32 v17, s25, v16
  ds_read_b128 v[96:99], v17 offset:4096
  ds_read_b128 v[100:103], v17 offset:5120
  ds_read_b128 v[104:107], v17 offset:6144
  ds_read_b128 v[108:111], v17 offset:7168
  s_xor_b32 s25, s22, 3
  s_mul_i32 s25, s25, 24576
  v_add_u32 v17, s25, v16
  ds_read_b128 v[112:115], v17 offset:8192
  ds_read_b128 v[116:119], v17 offset:9216
  ds_read_b128 v[120:123], v17 offset:10240
  ds_read_b128 v[124:127], v17 offset:11264
  s_mov_b32 s26, 0xbdd2d3e8
  v_mov_b32 v145, 0xc0135761
  v_add_u32 v14, s24, v14
  v_mul_u32_u24 v14, 144, v14
  v_lshrrev_b32 v15, 5, v1
  v_lshl_add_u32 v14, v15, 3, v14
  s_lshr_b32 s25, s22, 1
  s_lshl_b32 s25, s25, 6
  s_add_u32 s25, s25, 61440
  v_add_u32 v14, s25, v14
  s_waitcnt lgkmcnt(0)
  v_lshlrev_b32 v144, 16, v144
  v_add_f32 v64, v64, v80
  v_add_f32 v96, v96, v112
  v_add_f32 v65, v65, v81
  v_add_f32 v97, v97, v113
  v_add_f32 v66, v66, v82
  v_add_f32 v98, v98, v114
  v_add_f32 v67, v67, v83
  v_add_f32 v99, v99, v115
  v_add_f32 v68, v68, v84
  v_add_f32 v100, v100, v116
  v_add_f32 v69, v69, v85
  v_add_f32 v101, v101, v117
  v_add_f32 v70, v70, v86
  v_add_f32 v102, v102, v118
  v_add_f32 v71, v71, v87
  v_add_f32 v103, v103, v119
  v_add_f32 v72, v72, v88
  v_add_f32 v104, v104, v120
  v_add_f32 v73, v73, v89
  v_add_f32 v105, v105, v121
  v_add_f32 v74, v74, v90
  v_add_f32 v106, v106, v122
  v_add_f32 v75, v75, v91
  v_add_f32 v107, v107, v123
  v_add_f32 v76, v76, v92
  v_add_f32 v108, v108, v124
  v_add_f32 v77, v77, v93
  v_add_f32 v109, v109, v125
  v_add_f32 v78, v78, v94
  v_add_f32 v110, v110, v126
  v_add_f32 v79, v79, v95
  v_add_f32 v111, v111, v127
  v_add_f32 v64, v64, v144
  v_add_f32 v64, v64, v96
  v_add_f32 v65, v65, v144
  v_add_f32 v65, v65, v97
  v_add_f32 v66, v66, v144
  v_add_f32 v66, v66, v98
  v_add_f32 v67, v67, v144
  v_add_f32 v67, v67, v99
  v_add_f32 v68, v68, v144
  v_add_f32 v68, v68, v100
  v_add_f32 v69, v69, v144
  v_add_f32 v69, v69, v101
  v_add_f32 v70, v70, v144
  v_add_f32 v70, v70, v102
  v_add_f32 v71, v71, v144
  v_add_f32 v71, v71, v103
  v_add_f32 v72, v72, v144
  v_add_f32 v72, v72, v104
  v_add_f32 v73, v73, v144
  v_add_f32 v73, v73, v105
  v_add_f32 v74, v74, v144
  v_add_f32 v74, v74, v106
  v_add_f32 v75, v75, v144
  v_add_f32 v75, v75, v107
  v_add_f32 v76, v76, v144
  v_add_f32 v76, v76, v108
  v_add_f32 v77, v77, v144
  v_add_f32 v77, v77, v109
  v_add_f32 v78, v78, v144
  v_add_f32 v78, v78, v110
  v_add_f32 v79, v79, v144
  v_add_f32 v79, v79, v111
  v_mul_f32 v128, v64, v64
  v_mul_f32 v129, v65, v65
  v_mul_f32 v130, v66, v66
  v_mul_f32 v131, v67, v67
  v_fma_f32 v128, v128, s26, v145
  v_fma_f32 v129, v129, s26, v145
  v_fma_f32 v130, v130, s26, v145
  v_fma_f32 v131, v131, s26, v145
  v_mul_f32 v128, v128, v64
  v_mul_f32 v129, v129, v65
  v_mul_f32 v130, v130, v66
  v_mul_f32 v131, v131, v67
  v_exp_f32 v128, v128
  v_exp_f32 v129, v129
  v_exp_f32 v130, v130
  v_exp_f32 v131, v131
  v_add_f32 v128, 1.0, v128
  v_add_f32 v129, 1.0, v129
  v_add_f32 v130, 1.0, v130
  v_add_f32 v131, 1.0, v131
  v_rcp_f32 v128, v128
  v_rcp_f32 v129, v129
  v_rcp_f32 v130, v130
  v_rcp_f32 v131, v131
  s_nop 0
  v_mul_f32 v64, v64, v128
  v_mul_f32 v65, v65, v129
  v_mul_f32 v66, v66, v130
  v_mul_f32 v67, v67, v131
  v_cvt_pk_bf16_f32 v64, v64, v65
  v_cvt_pk_bf16_f32 v65, v66, v67
  ds_write_b64 v14, v[64:65] offset:0
  v_mul_f32 v128, v68, v68
  v_mul_f32 v129, v69, v69
  v_mul_f32 v130, v70, v70
  v_mul_f32 v131, v71, v71
  v_fma_f32 v128, v128, s26, v145
  v_fma_f32 v129, v129, s26, v145
  v_fma_f32 v130, v130, s26, v145
  v_fma_f32 v131, v131, s26, v145
  v_mul_f32 v128, v128, v68
  v_mul_f32 v129, v129, v69
  v_mul_f32 v130, v130, v70
  v_mul_f32 v131, v131, v71
  v_exp_f32 v128, v128
  v_exp_f32 v129, v129
  v_exp_f32 v130, v130
  v_exp_f32 v131, v131
  v_add_f32 v128, 1.0, v128
  v_add_f32 v129, 1.0, v129
  v_add_f32 v130, 1.0, v130
  v_add_f32 v131, 1.0, v131
  v_rcp_f32 v128, v128
  v_rcp_f32 v129, v129
  v_rcp_f32 v130, v130
  v_rcp_f32 v131, v131
  s_nop 0
  v_mul_f32 v68, v68, v128
  v_mul_f32 v69, v69, v129
  v_mul_f32 v70, v70, v130
  v_mul_f32 v71, v71, v131
  v_cvt_pk_bf16_f32 v68, v68, v69
  v_cvt_pk_bf16_f32 v69, v70, v71
  ds_write_b64 v14, v[68:69] offset:16
  v_mul_f32 v128, v72, v72
  v_mul_f32 v129, v73, v73
  v_mul_f32 v130, v74, v74
  v_mul_f32 v131, v75, v75
  v_fma_f32 v128, v128, s26, v145
  v_fma_f32 v129, v129, s26, v145
  v_fma_f32 v130, v130, s26, v145
  v_fma_f32 v131, v131, s26, v145
  v_mul_f32 v128, v128, v72
  v_mul_f32 v129, v129, v73
  v_mul_f32 v130, v130, v74
  v_mul_f32 v131, v131, v75
  v_exp_f32 v128, v128
  v_exp_f32 v129, v129
  v_exp_f32 v130, v130
  v_exp_f32 v131, v131
  v_add_f32 v128, 1.0, v128
  v_add_f32 v129, 1.0, v129
  v_add_f32 v130, 1.0, v130
  v_add_f32 v131, 1.0, v131
  v_rcp_f32 v128, v128
  v_rcp_f32 v129, v129
  v_rcp_f32 v130, v130
  v_rcp_f32 v131, v131
  s_nop 0
  v_mul_f32 v72, v72, v128
  v_mul_f32 v73, v73, v129
  v_mul_f32 v74, v74, v130
  v_mul_f32 v75, v75, v131
  v_cvt_pk_bf16_f32 v72, v72, v73
  v_cvt_pk_bf16_f32 v73, v74, v75
  ds_write_b64 v14, v[72:73] offset:32
  v_mul_f32 v128, v76, v76
  v_mul_f32 v129, v77, v77
  v_mul_f32 v130, v78, v78
  v_mul_f32 v131, v79, v79
  v_fma_f32 v128, v128, s26, v145
  v_fma_f32 v129, v129, s26, v145
  v_fma_f32 v130, v130, s26, v145
  v_fma_f32 v131, v131, s26, v145
  v_mul_f32 v128, v128, v76
  v_mul_f32 v129, v129, v77
  v_mul_f32 v130, v130, v78
  v_mul_f32 v131, v131, v79
  v_exp_f32 v128, v128
  v_exp_f32 v129, v129
  v_exp_f32 v130, v130
  v_exp_f32 v131, v131
  v_add_f32 v128, 1.0, v128
  v_add_f32 v129, 1.0, v129
  v_add_f32 v130, 1.0, v130
  v_add_f32 v131, 1.0, v131
  v_rcp_f32 v128, v128
  v_rcp_f32 v129, v129
  v_rcp_f32 v130, v130
  v_rcp_f32 v131, v131
  s_nop 0
  v_mul_f32 v76, v76, v128
  v_mul_f32 v77, v77, v129
  v_mul_f32 v78, v78, v130
  v_mul_f32 v79, v79, v131
  v_cvt_pk_bf16_f32 v76, v76, v77
  v_cvt_pk_bf16_f32 v77, v78, v79
  ds_write_b64 v14, v[76:77] offset:48
  v_lshrrev_b32 v15, 3, v1
  s_lshl_b32 s25, s22, 4
  v_add_u32 v15, s25, v15
  v_and_b32 v16, 7, v1
  v_mul_u32_u24 v17, 144, v15
  v_lshl_add_u32 v17, v16, 4, v17
  v_add_u32 v17, 61440, v17
  s_lshr_b32 s25, s42, 3
  v_add_u32 v19, s25, v16
  v_mul_u32_u24 v20, 205, v19
  v_lshrrev_b32 v20, 11, v20
  v_mul_u32_u24 v21, 10, v20
  v_sub_u32 v19, v19, v21
  s_mov_b32 s25, 348160
  v_mul_lo_u32 v20, v20, s25
  v_lshl_add_u32 v20, v19, 4, v20
  v_mul_u32_u24 v18, 160, v15
  v_add_u32 v18, v18, v20
  s_mul_i32 s25, s43, 160
  s_add_u32 s25, s25, 10485760
  s_add_u32 s26, s25, 1280
  v_mov_b32 v22, 155404
  v_mov_b32 v23, 1
  s_waitcnt lgkmcnt(0)
  s_mov_b64 exec, 1
  ds_add_u32 v22, v23
  s_mov_b64 exec, -1
  s_mov_b32 s28, 0
Lb_sync_6:
  ds_read_b32 v23, v22
  s_waitcnt lgkmcnt(0)
  v_readfirstlane_b32 s27, v23
  s_add_u32 s28, s28, 1
  s_nop 2
  s_cmp_ge_u32 s27, 4
  s_cbranch_scc1 Lb_sync_6_done
  s_sleep 1
  s_cmp_lt_u32 s28, 0x400000
  s_cbranch_scc1 Lb_sync_6
Lb_sync_6_done:
  ds_read_b128 v[128:131], v17
  ds_read_b128 v[132:135], v17 offset:1152
  s_waitcnt lgkmcnt(1)
  buffer_store_dwordx4 v[128:131], v18, s[16:19], s25 offen sc1
  s_waitcnt lgkmcnt(0)
  buffer_store_dwordx4 v[132:135], v18, s[16:19], s26 offen sc1
  s_lshr_b32 s28, s42, 6
  s_mul_i32 s28, s28, 24
  s_lshr_b32 s29, s43, 6
  s_add_u32 s28, s28, s29
  s_lshl_b32 s28, s28, 7
  s_add_u32 s28, s28, 16318464
  s_mov_b32 s29, 20
  s_branch Lb_done
Lb_wo:
  s_load_dwordx2 s[46:47], s[0:1], 16
  s_sub_u32 s24, s24, 30
  s_and_b32 s25, s2, 7
  s_lshl_b32 s25, s25, 1
  s_add_u32 s24, s24, s25
  s_lshl_b32 s62, s24, 7
  s_add_u32 s62, s62, 16384000
  v_mov_b32 v8, 155432
  ds_read_b32 v9, v8
  s_waitcnt lgkmcnt(0)
  v_readfirstlane_b32 s101, v9
  s_nop 3
  s_mul_i32 s24, s24, 40
  s_mul_i32 s25, s24, 1280
  s_add_u32 s26, s24, 1536
  s_mul_i32 s26, s26, 160
  s_add_u32 s26, s26, 10485760
  s_mov_b32 s27, 348160
  s_movk_i32 s28, 3277
  v_add_u32 v2, 0, v0
  v_mul_u32_u24 v3, s28, v2
  v_lshrrev_b32 v3, 18, v3
  v_mul_u32_u24 v4, 80, v3
  v_sub_u32 v4, v2, v4
  v_mul_u32_u24 v5, 205, v4
  v_lshrrev_b32 v5, 11, v5
  v_mul_u32_u24 v6, 10, v5
  v_sub_u32 v6, v4, v6
  v_mul_lo_u32 v5, v5, s27
  v_lshl_add_u32 v5, v6, 4, v5
  v_mul_u32_u24 v6, 160, v3
  v_add_u32 v16, v5, v6
  v_lshlrev_b32 v32, 4, v2
  v_add_u32 v2, 256, v0
  v_mul_u32_u24 v3, s28, v2
  v_lshrrev_b32 v3, 18, v3
  v_mul_u32_u24 v4, 80, v3
  v_sub_u32 v4, v2, v4
  v_mul_u32_u24 v5, 205, v4
  v_lshrrev_b32 v5, 11, v5
  v_mul_u32_u24 v6, 10, v5
  v_sub_u32 v6, v4, v6
  v_mul_lo_u32 v5, v5, s27
  v_lshl_add_u32 v5, v6, 4, v5
  v_mul_u32_u24 v6, 160, v3
  v_add_u32 v17, v5, v6
  v_lshlrev_b32 v33, 4, v2
  v_add_u32 v2, 512, v0
  v_mul_u32_u24 v3, s28, v2
  v_lshrrev_b32 v3, 18, v3
  v_mul_u32_u24 v4, 80, v3
  v_sub_u32 v4, v2, v4
  v_mul_u32_u24 v5, 205, v4
  v_lshrrev_b32 v5, 11, v5
  v_mul_u32_u24 v6, 10, v5
  v_sub_u32 v6, v4, v6
  v_mul_lo_u32 v5, v5, s27
  v_lshl_add_u32 v5, v6, 4, v5
  v_mul_u32_u24 v6, 160, v3
  v_add_u32 v18, v5, v6
  v_lshlrev_b32 v34, 4, v2
  v_add_u32 v2, 768, v0
  v_mul_u32_u24 v3, s28, v2
  v_lshrrev_b32 v3, 18, v3
  v_mul_u32_u24 v4, 80, v3
  v_sub_u32 v4, v2, v4
  v_mul_u32_u24 v5, 205, v4
  v_lshrrev_b32 v5, 11, v5
  v_mul_u32_u24 v6, 10, v5
  v_sub_u32 v6, v4, v6
  v_mul_lo_u32 v5, v5, s27
  v_lshl_add_u32 v5, v6, 4, v5
  v_mul_u32_u24 v6, 160, v3
  v_add_u32 v19, v5, v6
  v_lshlrev_b32 v35, 4, v2
  v_add_u32 v2, 1024, v0
  v_mul_u32_u24 v3, s28, v2
  v_lshrrev_b32 v3, 18, v3
  v_mul_u32_u24 v4, 80, v3
  v_sub_u32 v4, v2, v4
  v_mul_u32_u24 v5, 205, v4
  v_lshrrev_b32 v5, 11, v5
  v_mul_u32_u24 v6, 10, v5
  v_sub_u32 v6, v4, v6
  v_mul_lo_u32 v5, v5, s27
  v_lshl_add_u32 v5, v6, 4, v5
  v_mul_u32_u24 v6, 160, v3
  v_add_u32 v20, v5, v6
  v_lshlrev_b32 v36, 4, v2
  v_add_u32 v2, 1280, v0
  v_mul_u32_u24 v3, s28, v2
  v_lshrrev_b32 v3, 18, v3
  v_mul_u32_u24 v4, 80, v3
  v_sub_u32 v4, v2, v4
  v_mul_u32_u24 v5, 205, v4
  v_lshrrev_b32 v5, 11, v5
  v_mul_u32_u24 v6, 10, v5
  v_sub_u32 v6, v4, v6
  v_mul_lo_u32 v5, v5, s27
  v_lshl_add_u32 v5, v6, 4, v5
  v_mul_u32_u24 v6, 160, v3
  v_add_u32 v21, v5, v6
  v_lshlrev_b32 v37, 4, v2
  v_add_u32 v2, 1536, v0
  v_mul_u32_u24 v3, s28, v2
  v_lshrrev_b32 v3, 18, v3
  v_mul_u32_u24 v4, 80, v3
  v_sub_u32 v4, v2, v4
  v_mul_u32_u24 v5, 205, v4
  v_lshrrev_b32 v5, 11, v5
  v_mul_u32_u24 v6, 10, v5
  v_sub_u32 v6, v4, v6
  v_mul_lo_u32 v5, v5, s27
  v_lshl_add_u32 v5, v6, 4, v5
  v_mul_u32_u24 v6, 160, v3
  v_add_u32 v22, v5, v6
  v_lshlrev_b32 v38, 4, v2
  v_add_u32 v2, 1792, v0
  v_mul_u32_u24 v3, s28, v2
  v_lshrrev_b32 v3, 18, v3
  v_mul_u32_u24 v4, 80, v3
  v_sub_u32 v4, v2, v4
  v_mul_u32_u24 v5, 205, v4
  v_lshrrev_b32 v5, 11, v5
  v_mul_u32_u24 v6, 10, v5
  v_sub_u32 v6, v4, v6
  v_mul_lo_u32 v5, v5, s27
  v_lshl_add_u32 v5, v6, 4, v5
  v_mul_u32_u24 v6, 160, v3
  v_add_u32 v23, v5, v6
  v_lshlrev_b32 v39, 4, v2
  v_add_u32 v2, 2048, v0
  v_mul_u32_u24 v3, s28, v2
  v_lshrrev_b32 v3, 18, v3
  v_mul_u32_u24 v4, 80, v3
  v_sub_u32 v4, v2, v4
  v_mul_u32_u24 v5, 205, v4
  v_lshrrev_b32 v5, 11, v5
  v_mul_u32_u24 v6, 10, v5
  v_sub_u32 v6, v4, v6
  v_mul_lo_u32 v5, v5, s27
  v_lshl_add_u32 v5, v6, 4, v5
  v_mul_u32_u24 v6, 160, v3
  v_add_u32 v24, v5, v6
  v_lshlrev_b32 v40, 4, v2
  v_add_u32 v2, 2304, v0
  v_mul_u32_u24 v3, s28, v2
  v_lshrrev_b32 v3, 18, v3
  v_mul_u32_u24 v4, 80, v3
  v_sub_u32 v4, v2, v4
  v_mul_u32_u24 v5, 205, v4
  v_lshrrev_b32 v5, 11, v5
  v_mul_u32_u24 v6, 10, v5
  v_sub_u32 v6, v4, v6
  v_mul_lo_u32 v5, v5, s27
  v_lshl_add_u32 v5, v6, 4, v5
  v_mul_u32_u24 v6, 160, v3
  v_add_u32 v25, v5, v6
  v_lshlrev_b32 v41, 4, v2
  v_add_u32 v2, 2560, v0
  v_mul_u32_u24 v3, s28, v2
  v_lshrrev_b32 v3, 18, v3
  v_mul_u32_u24 v4, 80, v3
  v_sub_u32 v4, v2, v4
  v_mul_u32_u24 v5, 205, v4
  v_lshrrev_b32 v5, 11, v5
  v_mul_u32_u24 v6, 10, v5
  v_sub_u32 v6, v4, v6
  v_mul_lo_u32 v5, v5, s27
  v_lshl_add_u32 v5, v6, 4, v5
  v_mul_u32_u24 v6, 160, v3
  v_add_u32 v26, v5, v6
  v_lshlrev_b32 v42, 4, v2
  v_add_u32 v2, 2816, v0
  v_mul_u32_u24 v3, s28, v2
  v_lshrrev_b32 v3, 18, v3
  v_mul_u32_u24 v4, 80, v3
  v_sub_u32 v4, v2, v4
  v_mul_u32_u24 v5, 205, v4
  v_lshrrev_b32 v5, 11, v5
  v_mul_u32_u24 v6, 10, v5
  v_sub_u32 v6, v4, v6
  v_mul_lo_u32 v5, v5, s27
  v_lshl_add_u32 v5, v6, 4, v5
  v_mul_u32_u24 v6, 160, v3
  v_add_u32 v27, v5, v6
  v_lshlrev_b32 v43, 4, v2
  v_add_u32 v2, 3072, v0
  v_mul_u32_u24 v3, s28, v2
  v_lshrrev_b32 v3, 18, v3
  v_mul_u32_u24 v4, 80, v3
  v_sub_u32 v4, v2, v4
  v_mul_u32_u24 v5, 205, v4
  v_lshrrev_b32 v5, 11, v5
  v_mul_u32_u24 v6, 10, v5
  v_sub_u32 v6, v4, v6
  v_mul_lo_u32 v5, v5, s27
  v_lshl_add_u32 v5, v6, 4, v5
  v_mul_u32_u24 v6, 160, v3
  v_add_u32 v28, v5, v6
  v_lshlrev_b32 v44, 4, v2
  s_waitcnt lgkmcnt(0)
  s_mov_b32 s8, s46
  s_and_b32 s9, s47, 0xffff
  s_mov_b32 s10, 819200
  s_mov_b32 s11, 0x20000
  s_mov_b32 s12, s20
  s_and_b32 s13, s21, 0xffff
  s_mov_b32 s14, 16252928
  s_mov_b32 s15, 0x20000
  v_cmp_gt_u32 vcc, 128, v0
  buffer_load_dwordx4 v[48:51], v32, s[8:11], s25 offen
  buffer_load_dwordx4 v[52:55], v33, s[8:11], s25 offen
  buffer_load_dwordx4 v[56:59], v34, s[8:11], s25 offen
  buffer_load_dwordx4 v[60:63], v35, s[8:11], s25 offen
  buffer_load_dwordx4 v[64:67], v36, s[8:11], s25 offen
  buffer_load_dwordx4 v[68:71], v37, s[8:11], s25 offen
  buffer_load_dwordx4 v[72:75], v38, s[8:11], s25 offen
  buffer_load_dwordx4 v[76:79], v39, s[8:11], s25 offen
  buffer_load_dwordx4 v[80:83], v40, s[8:11], s25 offen
  buffer_load_dwordx4 v[84:87], v41, s[8:11], s25 offen
  buffer_load_dwordx4 v[88:91], v42, s[8:11], s25 offen
  buffer_load_dwordx4 v[92:95], v43, s[8:11], s25 offen
  s_and_saveexec_b64 s[44:45], vcc
  s_cbranch_execz Lb_wo_a
  buffer_load_dwordx4 v[96:99], v44, s[8:11], s25 offen
Lb_wo_a:
  s_mov_b64 exec, s[44:45]
  s_waitcnt vmcnt(0)
  buffer_store_dwordx4 v[48:51], v16, s[12:15], s26 offen sc1
  buffer_store_dwordx4 v[52:55], v17, s[12:15], s26 offen sc1
  buffer_store_dwordx4 v[56:59], v18, s[12:15], s26 offen sc1
  buffer_store_dwordx4 v[60:63], v19, s[12:15], s26 offen sc1
  buffer_store_dwordx4 v[64:67], v20, s[12:15], s26 offen sc1
  buffer_store_dwordx4 v[68:71], v21, s[12:15], s26 offen sc1
  buffer_store_dwordx4 v[72:75], v22, s[12:15], s26 offen sc1
  buffer_store_dwordx4 v[76:79], v23, s[12:15], s26 offen sc1
  buffer_store_dwordx4 v[80:83], v24, s[12:15], s26 offen sc1
  buffer_store_dwordx4 v[84:87], v25, s[12:15], s26 offen sc1
  buffer_store_dwordx4 v[88:91], v26, s[12:15], s26 offen sc1
  buffer_store_dwordx4 v[92:95], v27, s[12:15], s26 offen sc1
  s_and_saveexec_b64 s[44:45], vcc
  s_cbranch_execz Lb_wo_b
  buffer_store_dwordx4 v[96:99], v28, s[12:15], s26 offen sc1
Lb_wo_b:
  s_mov_b64 exec, s[44:45]
  s_mov_b32 s28, s62
  s_mov_b32 s29, 20
  s_mov_b32 s30, 0
  s_cmp_eq_u32 s22, 0
  s_cbranch_scc0 Lb_done
  s_lshr_b32 s52, s2, 3
  s_mul_i32 s53, s52, 48
  v_lshrrev_b32 v224, 2, v1
  v_add_u32 v224, s53, v224
  v_lshlrev_b32 v224, 12, v224
  v_and_b32 v225, 3, v1
  v_lshl_add_u32 v224, v225, 7, v224
  s_and_b32 s53, s2, 7
  s_lshl_b32 s53, s53, 9
  s_mov_b32 s56, s34
  s_and_b32 s57, s35, 0xffff
  s_mov_b32 s58, 6291456
  s_mov_b32 s59, 0x20000
  buffer_load_dword v240, v224, s[56:59], s53 offen
  s_add_u32 s53, s53, 65536
  buffer_load_dword v241, v224, s[56:59], s53 offen
  s_add_u32 s53, s53, 65536
  buffer_load_dword v242, v224, s[56:59], s53 offen
  s_add_u32 s53, s53, 65536
  s_branch Lb_done
Lb_att:
  s_setprio 3
  s_sub_u32 s22, s22, 4
  s_lshr_b32 s24, s2, 3
  s_and_b32 s12, s24, 7
  s_lshr_b32 s24, s24, 3
  s_and_b32 s13, s2, 7
  s_lshl_b32 s13, s13, 2
  s_add_u32 s13, s13, s24
  s_mul_i32 s25, s13, 81920
  s_lshl_b32 s24, s12, 8
  s_lshl_b32 s26, s22, 7
  s_add_u32 s24, s24, s26
  s_sub_u32 s24, s24, 256
  s_mul_i32 s24, s24, 40
  s_add_u32 s26, s24, s25
  s_add_u32 s26, s26, 2621440
  v_lshlrev_b32 v15, 4, v1
  v_and_b32 v16, 31, v1
  v_lshrrev_b32 v17, 5, v1
  s_lshl_b32 s28, s12, 8
  s_lshl_b32 s29, s22, 6
  s_add_u32 s28, s28, s29
  v_add_u32 v18, s28, v16
  v_mul_u32_u24 v18, 40, v18
  v_lshl_add_u32 v18, v17, 4, v18
  v_add_u32 v18, s25, v18
  v_mov_b32 v224, 0
  v_mov_b32 v225, 0
  v_mov_b32 v226, 0
  v_mov_b32 v227, 0
  v_mov_b32 v228, 0
  v_mov_b32 v229, 0
  v_mov_b32 v230, 0
  v_mov_b32 v231, 0
  v_mov_b32 v232, 0
  v_mov_b32 v233, 0
  v_mov_b32 v234, 0
  v_mov_b32 v235, 0
  v_mov_b32 v236, 0
  v_mov_b32 v237, 0
  v_mov_b32 v238, 0
  v_mov_b32 v239, 0
  v_mov_b32 v214, 0
  v_mov_b32 v215, 0
  v_mov_b32 v222, 0
  v_mov_b32 v223, 0
  s_waitcnt lgkmcnt(0)
  s_waitcnt vmcnt(0)
  v_mov_b32 v24, 155408
  v_mov_b32 v25, 1
  s_mov_b64 exec, 1
  ds_add_u32 v24, v25
  s_mov_b64 exec, -1
  s_cmp_eq_u32 s22, 0
  s_cbranch_scc0 Lb_att_qwait
  v_mov_b32 v24, 155432
  ds_read_b32 v25, v24
  s_waitcnt lgkmcnt(0)
  v_readfirstlane_b32 s101, v25
  s_nop 3
  s_mov_b32 s40, s20
  s_and_b32 s41, s21, 0xffff
  s_mov_b32 s42, 16388096
  s_mov_b32 s43, 0x20000
  s_bitcmp1_b32 s3, 16
  s_cbranch_scc1 Lb_att_norep
  v_mov_b32 v24, 155408
  s_mov_b32 s39, 0
Lrep_7:
  ds_read_b32 v25, v24
  s_waitcnt lgkmcnt(0)
  v_readfirstlane_b32 s38, v25
  s_add_u32 s39, s39, 1
  s_nop 2
  s_cmp_ge_u32 s38, 4
  s_cbranch_scc1 Lrep_7_all
  s_sleep 1
  s_cmp_lt_u32 s39, 0x400000
  s_cbranch_scc1 Lrep_7
Lrep_7_all:
  s_and_b32 s38, s3, 0xff
  s_lshl_b32 s38, s38, 7
  s_add_u32 s38, s38, 16269312
  v_mov_b32 v24, s38
  v_mov_b32 v25, s101
  s_mov_b64 exec, 1
  buffer_store_dword v25, v24, s[40:43], 0 offen sc1
  s_mov_b64 exec, -1
Lb_att_norep:
  s_mul_i32 s44, s13, 20
  s_add_u32 s45, s44, 19
  s_lshr_b32 s44, s44, 7
  s_lshr_b32 s45, s45, 7
  s_lshl_b32 s44, 1, s44
  s_lshl_b32 s45, 1, s45
  s_or_b32 s44, s44, s45
  s_mul_i32 s44, s44, 0x421
  s_mul_i32 s44, s44, 0x10001
  s_mov_b32 s45, s44
  s_max_u32 s46, s12, 1
  s_sub_u32 s46, s46, 1
  s_lshl_b32 s46, s46, 12
  s_add_u32 s46, s46, 16269312
  v_lshlrev_b32 v24, 7, v1
  v_add_u32 v24, s46, v24
  s_mov_b32 s38, 0
Lpt_8:
  s_mov_b64 exec, s[44:45]
  buffer_load_dword v25, v24, s[40:43], 0 offen sc1
  s_mov_b64 exec, -1
  s_waitcnt vmcnt(0)
Lpt_8_chk:
  v_cmp_ne_u32 vcc, s101, v25
  s_nop 4
  s_and_b64 vcc, vcc, s[44:45]
  s_cmp_eq_u64 vcc, 0
  s_cbranch_scc1 Lpt_8_ok
  s_add_u32 s38, s38, 1
  s_sleep 10
  s_cmp_lt_u32 s38, 200000
  s_cbranch_scc1 Lpt_8
Lpt_8_ok:
  v_mov_b32 v24, 155420
  v_mov_b32 v25, 1
  ds_write_b32 v24, v25
  s_branch Lb_att_qok
Lb_att_qwait:
  v_mov_b32 v24, 155420
  s_mov_b32 s39, 0
Lgo_9:
  ds_read_b32 v25, v24
  s_waitcnt lgkmcnt(0)
  v_readfirstlane_b32 s38, v25
  s_add_u32 s39, s39, 1
  s_nop 2
  s_cmp_lg_u32 s38, 0
  s_cbranch_scc1 Lgo_9_ok
  s_sleep 2
  s_cmp_lt_u32 s39, 0x400000
  s_cbranch_scc1 Lgo_9
Lgo_9_ok:
Lb_att_qok:
  s_mov_b32 s8, s20
  s_and_b32 s9, s21, 0xffff
  s_mov_b32 s10, 16252928
  s_mov_b32 s11, 0x20000
  s_mov_b32 s30, 0
  buffer_load_dwordx4 v[224:227], v18, s[8:11], s30 offen sc1
  s_mov_b32 s30, 1280
  buffer_load_dwordx4 v[232:235], v18, s[8:11], s30 offen sc1
  v_lshlrev_b32 v17, 4, v17
  v_sub_u32 v19, v18, v17
  s_mov_b32 exec_hi, 0
  s_mov_b32 s30, 0
  buffer_load_dwordx2 v[228:229], v19, s[8:11], s30 offen offset:32 sc1
  s_mov_b32 s30, 1280
  buffer_load_dwordx2 v[236:237], v19, s[8:11], s30 offen offset:32 sc1
  s_mov_b32 exec_hi, -1
  s_cmp_eq_u32 s12, 0
  s_cselect_b32 s30, 2, 0
  s_cmp_lt_u32 s22, s30
  s_cbranch_scc1 Lb_nok
  s_mul_i32 s30, s22, 5120
  s_add_u32 m0, s30, 98304
  s_nop 0
  buffer_load_dwordx4 v15, s[8:11], s26 offen offset:0 sc1 lds
  buffer_load_dwordx4 v15, s[8:11], s26 offen offset:1024 sc1 lds
  buffer_load_dwordx4 v15, s[8:11], s26 offen offset:2048 sc1 lds
  buffer_load_dwordx4 v15, s[8:11], s26 offen offset:3072 sc1 lds
  s_add_u32 m0, s30, 102400
  s_add_u32 s26, s26, 4096
  buffer_load_dwordx4 v15, s[8:11], s26 offen sc1 lds
Lb_nok:
  s_mul_i32 s24, s13, 20
  s_mul_i32 s25, s22, 5
  s_add_u32 s24, s24, s25
  s_lshl_b32 s24, s24, 12
  s_lshl_b32 s26, s12, 9
  s_add_u32 s24, s24, s26
  s_add_u32 s24, s24, 5242368
  s_mul_i32 s25, s25, 1040
  s_add_u32 m0, s25, 122880
  s_nop 0
  buffer_load_dwordx4 v15, s[8:11], s24 offen sc1 lds
  s_add_u32 s24, s24, 4096
  s_add_u32 m0, s25, 123920
  s_nop 0
  buffer_load_dwordx4 v15, s[8:11], s24 offen sc1 lds
  s_add_u32 s24, s24, 4096
  s_add_u32 m0, s25, 124960
  s_nop 0
  buffer_load_dwordx4 v15, s[8:11], s24 offen sc1 lds
  s_add_u32 s24, s24, 4096
  s_add_u32 m0, s25, 126000
  s_nop 0
  buffer_load_dwordx4 v15, s[8:11], s24 offen sc1 lds
  s_add_u32 s24, s24, 4096
  s_add_u32 m0, s25, 127040
  s_nop 0
  buffer_load_dwordx4 v15, s[8:11], s24 offen sc1 lds
  s_add_u32 s24, s24, 4096
  v_mov_b32 v8, 0x3f803f80
  v_mov_b32 v9, v8
  v_mov_b32 v10, v8
  v_mov_b32 v11, v8
  s_lshl_b32 s24, s22, 6
  v_add_u32 v13, s24, v1
  v_lshlrev_b32 v12, 4, v13
  v_add_u32 v12, 154112, v12
  v_cmp_gt_u32 vcc, 80, v13
  s_and_saveexec_b64 s[24:25], vcc
  ds_write_b128 v12, v[8:11]
  s_mov_b64 exec, s[24:25]
  v_and_b32 v8, 31, v1
  v_lshrrev_b32 v9, 5, v1
  v_and_b32 v10, 0x13, v8
  v_bfe_u32 v11, v8, 2, 1
  v_lshl_or_b32 v10, v11, 3, v10
  v_bfe_u32 v11, v8, 3, 1
  v_lshl_or_b32 v10, v11, 2, v10
  s_lshl_b32 s24, s22, 6
  v_add_u32 v10, s24, v10
  v_mul_u32_u24 v10, 40, v10
  v_add_u32 v10, 98304, v10
  v_lshl_add_u32 v2, v9, 4, v10
  v_add_u32 v3, 32, v10
  v_mul_u32_u24 v10, 1040, v8
  v_add_u32 v10, 122880, v10
  v_and_b32 v11, 15, v8
  v_lshlrev_b32 v11, 4, v11
  v_add_u32 v11, 154112, v11
  v_cmp_gt_u32 vcc, 20, v8
  s_lshl_b32 s24, s22, 7
  s_nop 0
  v_cndmask_b32 v10, v11, v10, vcc
  v_lshl_add_u32 v10, v9, 4, v10
  v_add_u32 v4, s24, v10
  v_lshlrev_b32 v10, 9, v9
  v_lshl_add_u32 v10, v8, 1, v10
  s_mul_i32 s24, s22, 2560
  s_add_u32 s24, s24, 143872
  v_add_u32 v5, s24, v10
  v_lshlrev_b32 v10, 3, v9
  v_sub_u32 v10, v8, v10
  v_cmp_gt_i32_e64 s[36:37], 0, v10
  v_cmp_gt_i32_e64 s[38:39], 1, v10
  v_cmp_gt_i32_e64 s[40:41], 2, v10
  v_cmp_gt_i32_e64 s[42:43], 3, v10
  v_cmp_gt_i32_e64 s[44:45], 4, v10
  v_cmp_gt_i32_e64 s[46:47], 5, v10
  v_cmp_gt_i32_e64 s[48:49], 6, v10
  v_cmp_gt_i32_e64 s[50:51], 7, v10
  v_cmp_gt_i32_e64 s[52:53], 16, v10
  v_cmp_gt_i32_e64 s[54:55], 17, v10
  v_cmp_gt_i32_e64 s[56:57], 18, v10
  v_cmp_gt_i32_e64 s[58:59], 19, v10
  v_cmp_gt_i32_e64 s[60:61], 20, v10
  v_cmp_gt_i32_e64 s[62:63], 21, v10
  v_cmp_gt_i32_e64 s[64:65], 22, v10
  v_cmp_gt_i32_e64 s[66:67], 23, v10
  v_mov_b32 v11, 0xffff
  v_mov_b32 v12, 0xffff0000
  v_cndmask_b32_e64 v13, 0, v11, s[36:37]
  v_cndmask_b32_e64 v14, 0, v12, s[38:39]
  v_or_b32 v240, v13, v14
  v_cndmask_b32_e64 v13, 0, v11, s[40:41]
  v_cndmask_b32_e64 v14, 0, v12, s[42:43]
  v_or_b32 v241, v13, v14
  v_cndmask_b32_e64 v13, 0, v11, s[44:45]
  v_cndmask_b32_e64 v14, 0, v12, s[46:47]
  v_or_b32 v242, v13, v14
  v_cndmask_b32_e64 v13, 0, v11, s[48:49]
  v_cndmask_b32_e64 v14, 0, v12, s[50:51]
  v_or_b32 v243, v13, v14
  v_cndmask_b32_e64 v13, 0, v11, s[52:53]
  v_cndmask_b32_e64 v14, 0, v12, s[54:55]
  v_or_b32 v244, v13, v14
  v_cndmask_b32_e64 v13, 0, v11, s[56:57]
  v_cndmask_b32_e64 v14, 0, v12, s[58:59]
  v_or_b32 v245, v13, v14
  v_cndmask_b32_e64 v13, 0, v11, s[60:61]
  v_cndmask_b32_e64 v14, 0, v12, s[62:63]
  v_or_b32 v246, v13, v14
  v_cndmask_b32_e64 v13, 0, v11, s[64:65]
  v_cndmask_b32_e64 v14, 0, v12, s[66:67]
  v_or_b32 v247, v13, v14
  s_lshl_b32 s24, s22, 1
  s_sub_u32 s24, 8, s24
  s_cmp_eq_u32 s12, 0
  s_cselect_b32 s14, s24, 0
  s_mov_b32 s15, 0
  s_mov_b32 s32, 0xf149f2ca
  s_setprio 2
  s_waitcnt vmcnt(0)
  v_mov_b32 v8, 155392
  v_mov_b32 v9, 1
  s_waitcnt lgkmcnt(0)
  s_mov_b64 exec, 1
  ds_add_u32 v8, v9
  s_mov_b64 exec, -1
  s_mov_b32 s25, 0
Lb_sync_10:
  ds_read_b32 v9, v8
  s_waitcnt lgkmcnt(0)
  v_readfirstlane_b32 s24, v9
  s_add_u32 s25, s25, 1
  s_nop 2
  s_cmp_ge_u32 s24, 4
  s_cbranch_scc1 Lb_sync_10_done
  s_sleep 1
  s_cmp_lt_u32 s25, 0x400000
  s_cbranch_scc1 Lb_sync_10
Lb_sync_10_done:
Lb_att_tile:
  ds_read_b64 v[208:209], v2 offset:0
  ds_read_b64 v[210:211], v2 offset:8
  ds_read_b64 v[212:213], v3 offset:0
  s_waitcnt lgkmcnt(0)
  ds_read_b64 v[216:217], v2 offset:1280
  ds_read_b64 v[218:219], v2 offset:1288
  ds_read_b64 v[220:221], v3 offset:1280
  s_cmp_gt_u32 s14, 0
  s_cbranch_scc1 Lb_inv_0
  v_mfma_f32_32x32x16_bf16 v[64:79], v[208:211], v[224:227], 0
  v_mfma_f32_32x32x16_bf16 v[64:79], v[212:215], v[228:231], v[64:79]
Lb_invb_0:
  s_nop 7
  s_waitcnt lgkmcnt(0)
  ds_read_b64 v[208:209], v2 offset:2560
  ds_read_b64 v[210:211], v2 offset:2568
  ds_read_b64 v[212:213], v3 offset:2560
  s_cmp_gt_u32 s14, 1
  s_cbranch_scc1 Lb_inv_1
  v_mfma_f32_32x32x16_bf16 v[80:95], v[216:219], v[224:227], 0
  v_mfma_f32_32x32x16_bf16 v[80:95], v[220:223], v[228:231], v[80:95]
Lb_invb_1:
  s_nop 7
  s_waitcnt lgkmcnt(0)
  ds_read_b64 v[216:217], v2 offset:3840
  ds_read_b64 v[218:219], v2 offset:3848
  ds_read_b64 v[220:221], v3 offset:3840
  s_cmp_gt_u32 s14, 2
  s_cbranch_scc1 Lb_inv_2
  v_mfma_f32_32x32x16_bf16 v[96:111], v[208:211], v[224:227], 0
  v_mfma_f32_32x32x16_bf16 v[96:111], v[212:215], v[228:231], v[96:111]
Lb_invb_2:
  s_nop 7
  s_waitcnt lgkmcnt(0)
  ds_read_b64 v[208:209], v2 offset:5120
  ds_read_b64 v[210:211], v2 offset:5128
  ds_read_b64 v[212:213], v3 offset:5120
  s_cmp_gt_u32 s14, 3
  s_cbranch_scc1 Lb_inv_3
  v_mfma_f32_32x32x16_bf16 v[112:127], v[216:219], v[224:227], 0
  v_mfma_f32_32x32x16_bf16 v[112:127], v[220:223], v[228:231], v[112:127]
Lb_invb_3:
  v_max_f32 v6, v80, v81
  v_max3_f32 v6, v6, v82, v83
  v_max3_f32 v6, v6, v84, v85
  v_max3_f32 v6, v6, v86, v87
  v_max3_f32 v6, v6, v88, v89
  v_max3_f32 v6, v6, v90, v91
  v_max3_f32 v6, v6, v92, v93
  v_max3_f32 v6, v6, v94, v95
  s_waitcnt lgkmcnt(0)
  ds_read_b64 v[216:217], v2 offset:6400
  ds_read_b64 v[218:219], v2 offset:6408
  ds_read_b64 v[220:221], v3 offset:6400
  s_cmp_gt_u32 s14, 4
  s_cbranch_scc1 Lb_inv_4
  v_mfma_f32_32x32x16_bf16 v[128:143], v[208:211], v[224:227], 0
  v_mfma_f32_32x32x16_bf16 v[128:143], v[212:215], v[228:231], v[128:143]
Lb_invb_4:
  v_max3_f32 v6, v6, v96, v97
  v_max3_f32 v6, v6, v98, v99
  v_max3_f32 v6, v6, v100, v101
  v_max3_f32 v6, v6, v102, v103
  v_max3_f32 v6, v6, v104, v105
  v_max3_f32 v6, v6, v106, v107
  v_max3_f32 v6, v6, v108, v109
  v_max3_f32 v6, v6, v110, v111
  s_waitcnt lgkmcnt(0)
  ds_read_b64 v[208:209], v2 offset:7680
  ds_read_b64 v[210:211], v2 offset:7688
  ds_read_b64 v[212:213], v3 offset:7680
  s_cmp_gt_u32 s14, 5
  s_cbranch_scc1 Lb_inv_5
  v_mfma_f32_32x32x16_bf16 v[144:159], v[216:219], v[224:227], 0
  v_mfma_f32_32x32x16_bf16 v[144:159], v[220:223], v[228:231], v[144:159]
Lb_invb_5:
  v_max3_f32 v6, v6, v112, v113
  v_max3_f32 v6, v6, v114, v115
  v_max3_f32 v6, v6, v116, v117
  v_max3_f32 v6, v6, v118, v119
  v_max3_f32 v6, v6, v120, v121
  v_max3_f32 v6, v6, v122, v123
  v_max3_f32 v6, v6, v124, v125
  v_max3_f32 v6, v6, v126, v127
  s_waitcnt lgkmcnt(0)
  ds_read_b64 v[216:217], v2 offset:8960
  ds_read_b64 v[218:219], v2 offset:8968
  ds_read_b64 v[220:221], v3 offset:8960
  s_cmp_gt_u32 s14, 6
  s_cbranch_scc1 Lb_inv_6
  v_mfma_f32_32x32x16_bf16 v[160:175], v[208:211], v[224:227], 0
  v_mfma_f32_32x32x16_bf16 v[160:175], v[212:215], v[228:231], v[160:175]
Lb_invb_6:
  v_max3_f32 v6, v6, v128, v129
  v_max3_f32 v6, v6, v130, v131
  v_max3_f32 v6, v6, v132, v133
  v_max3_f32 v6, v6, v134, v135
  v_max3_f32 v6, v6, v136, v137
  v_max3_f32 v6, v6, v138, v139
  v_max3_f32 v6, v6, v140, v141
  v_max3_f32 v6, v6, v142, v143
  s_waitcnt lgkmcnt(0)
  ds_read_b64 v[208:209], v2 offset:10240
  ds_read_b64 v[210:211], v2 offset:10248
  ds_read_b64 v[212:213], v3 offset:10240
  s_cmp_gt_u32 s14, 7
  s_cbranch_scc1 Lb_inv_7
  v_mfma_f32_32x32x16_bf16 v[176:191], v[216:219], v[224:227], 0
  v_mfma_f32_32x32x16_bf16 v[176:191], v[220:223], v[228:231], v[176:191]
Lb_invb_7:
  v_max3_f32 v6, v6, v144, v145
  v_max3_f32 v6, v6, v146, v147
  v_max3_f32 v6, v6, v148, v149
  v_max3_f32 v6, v6, v150, v151
  v_max3_f32 v6, v6, v152, v153
  v_max3_f32 v6, v6, v154, v155
  v_max3_f32 v6, v6, v156, v157
  v_max3_f32 v6, v6, v158, v159
  s_waitcnt lgkmcnt(0)
  v_mfma_f32_32x32x16_bf16 v[192:207], v[208:211], v[224:227], 0
  v_mfma_f32_32x32x16_bf16 v[192:207], v[212:215], v[228:231], v[192:207]
  v_max3_f32 v6, v6, v160, v161
  v_max3_f32 v6, v6, v162, v163
  v_max3_f32 v6, v6, v164, v165
  v_max3_f32 v6, v6, v166, v167
  v_max3_f32 v6, v6, v168, v169
  v_max3_f32 v6, v6, v170, v171
  v_max3_f32 v6, v6, v172, v173
  v_max3_f32 v6, v6, v174, v175
  s_nop 3
  v_max3_f32 v6, v6, v176, v177
  v_max3_f32 v6, v6, v178, v179
  v_max3_f32 v6, v6, v180, v181
  v_max3_f32 v6, v6, v182, v183
  v_max3_f32 v6, v6, v184, v185
  v_max3_f32 v6, v6, v186, v187
  v_max3_f32 v6, v6, v188, v189
  v_max3_f32 v6, v6, v190, v191
  s_nop 3
  v_cndmask_b32_e64 v64, v192, v64, s[36:37]
  v_cndmask_b32_e64 v65, v193, v65, s[38:39]
  v_cndmask_b32_e64 v66, v194, v66, s[40:41]
  v_cndmask_b32_e64 v67, v195, v67, s[42:43]
  v_cndmask_b32_e64 v68, v196, v68, s[44:45]
  v_cndmask_b32_e64 v69, v197, v69, s[46:47]
  v_cndmask_b32_e64 v70, v198, v70, s[48:49]
  v_cndmask_b32_e64 v71, v199, v71, s[50:51]
  v_cndmask_b32_e64 v72, v200, v72, s[52:53]
  v_cndmask_b32_e64 v73, v201, v73, s[54:55]
  v_cndmask_b32_e64 v74, v202, v74, s[56:57]
  v_cndmask_b32_e64 v75, v203, v75, s[58:59]
  v_cndmask_b32_e64 v76, v204, v76, s[60:61]
  v_cndmask_b32_e64 v77, v205, v77, s[62:63]
  v_cndmask_b32_e64 v78, v206, v78, s[64:65]
  v_cndmask_b32_e64 v79, v207, v79, s[66:67]
  v_max3_f32 v6, v6, v64, v65
  v_max3_f32 v6, v6, v66, v67
  v_max3_f32 v6, v6, v68, v69
  v_max3_f32 v6, v6, v70, v71
  v_max3_f32 v6, v6, v72, v73
  v_max3_f32 v6, v6, v74, v75
  v_max3_f32 v6, v6, v76, v77
  v_max3_f32 v6, v6, v78, v79
  v_mov_b32 v7, v6
  s_nop 1
  v_permlane32_swap_b32 v6, v7
  v_mov_b32 v192, 0
  v_mov_b32 v193, 0
  v_mov_b32 v194, 0
  v_mov_b32 v195, 0
  v_mov_b32 v196, 0
  v_mov_b32 v197, 0
  v_mov_b32 v198, 0
  v_mov_b32 v199, 0
  v_mov_b32 v200, 0
  v_mov_b32 v201, 0
  v_mov_b32 v202, 0
  v_mov_b32 v203, 0
  v_mov_b32 v204, 0
  v_mov_b32 v205, 0
  v_mov_b32 v206, 0
  v_mov_b32 v207, 0
  v_max_f32 v6, v6, v7
  ds_read_b128 v[208:211], v4 offset:64
  ds_read_b128 v[212:215], v4 offset:96
  ds_read_b128 v[216:219], v4 offset:128
  ds_read_b128 v[220:223], v4 offset:160
  v_sub_f32 v80, v80, v6
  v_sub_f32 v81, v81, v6
  v_exp_f32 v80, v80
  v_sub_f32 v82, v82, v6
  v_exp_f32 v81, v81
  v_sub_f32 v83, v83, v6
  v_exp_f32 v82, v82
  v_sub_f32 v84, v84, v6
  v_exp_f32 v83, v83
  v_sub_f32 v85, v85, v6
  v_exp_f32 v84, v84
  v_sub_f32 v86, v86, v6
  v_exp_f32 v85, v85
  v_sub_f32 v87, v87, v6
  v_exp_f32 v86, v86
  v_sub_f32 v88, v88, v6
  v_exp_f32 v87, v87
  v_sub_f32 v89, v89, v6
  v_exp_f32 v88, v88
  v_sub_f32 v90, v90, v6
  v_exp_f32 v89, v89
  v_sub_f32 v91, v91, v6
  v_exp_f32 v90, v90
  v_sub_f32 v92, v92, v6
  v_exp_f32 v91, v91
  v_sub_f32 v93, v93, v6
  v_exp_f32 v92, v92
  v_sub_f32 v94, v94, v6
  v_exp_f32 v93, v93
  v_sub_f32 v95, v95, v6
  v_exp_f32 v94, v94
  v_exp_f32 v95, v95
  v_cvt_pk_bf16_f32 v80, v80, v81
  v_cvt_pk_bf16_f32 v81, v82, v83
  v_cvt_pk_bf16_f32 v82, v84, v85
  v_cvt_pk_bf16_f32 v83, v86, v87
  v_cvt_pk_bf16_f32 v84, v88, v89
  v_cvt_pk_bf16_f32 v85, v90, v91
  v_cvt_pk_bf16_f32 v86, v92, v93
  v_cvt_pk_bf16_f32 v87, v94, v95
  s_cmp_gt_u32 s14, 1
  s_cbranch_scc1 Lb_pvskip_1
  s_waitcnt lgkmcnt(2)
  v_mfma_f32_32x32x16_bf16 v[192:207], v[208:211], v[80:83], v[192:207]
  v_mfma_f32_32x32x16_bf16 v[192:207], v[212:215], v[84:87], v[192:207]
Lb_pvskip_1:
  ds_read_b128 v[208:211], v4 offset:192
  ds_read_b128 v[212:215], v4 offset:224
  v_sub_f32 v96, v96, v6
  v_sub_f32 v97, v97, v6
  v_exp_f32 v96, v96
  v_sub_f32 v98, v98, v6
  v_exp_f32 v97, v97
  v_sub_f32 v99, v99, v6
  v_exp_f32 v98, v98
  v_sub_f32 v100, v100, v6
  v_exp_f32 v99, v99
  v_sub_f32 v101, v101, v6
  v_exp_f32 v100, v100
  v_sub_f32 v102, v102, v6
  v_exp_f32 v101, v101
  v_sub_f32 v103, v103, v6
  v_exp_f32 v102, v102
  v_sub_f32 v104, v104, v6
  v_exp_f32 v103, v103
  v_sub_f32 v105, v105, v6
  v_exp_f32 v104, v104
  v_sub_f32 v106, v106, v6
  v_exp_f32 v105, v105
  v_sub_f32 v107, v107, v6
  v_exp_f32 v106, v106
  v_sub_f32 v108, v108, v6
  v_exp_f32 v107, v107
  v_sub_f32 v109, v109, v6
  v_exp_f32 v108, v108
  v_sub_f32 v110, v110, v6
  v_exp_f32 v109, v109
  v_sub_f32 v111, v111, v6
  v_exp_f32 v110, v110
  v_exp_f32 v111, v111
  v_cvt_pk_bf16_f32 v96, v96, v97
  v_cvt_pk_bf16_f32 v97, v98, v99
  v_cvt_pk_bf16_f32 v98, v100, v101
  v_cvt_pk_bf16_f32 v99, v102, v103
  v_cvt_pk_bf16_f32 v100, v104, v105
  v_cvt_pk_bf16_f32 v101, v106, v107
  v_cvt_pk_bf16_f32 v102, v108, v109
  v_cvt_pk_bf16_f32 v103, v110, v111
  s_cmp_gt_u32 s14, 2
  s_cbranch_scc1 Lb_pvskip_2
  s_waitcnt lgkmcnt(2)
  v_mfma_f32_32x32x16_bf16 v[192:207], v[216:219], v[96:99], v[192:207]
  v_mfma_f32_32x32x16_bf16 v[192:207], v[220:223], v[100:103], v[192:207]
Lb_pvskip_2:
  ds_read_b128 v[216:219], v4 offset:256
  ds_read_b128 v[220:223], v4 offset:288
  v_sub_f32 v112, v112, v6
  v_sub_f32 v113, v113, v6
  v_exp_f32 v112, v112
  v_sub_f32 v114, v114, v6
  v_exp_f32 v113, v113
  v_sub_f32 v115, v115, v6
  v_exp_f32 v114, v114
  v_sub_f32 v116, v116, v6
  v_exp_f32 v115, v115
  v_sub_f32 v117, v117, v6
  v_exp_f32 v116, v116
  v_sub_f32 v118, v118, v6
  v_exp_f32 v117, v117
  v_sub_f32 v119, v119, v6
  v_exp_f32 v118, v118
  v_sub_f32 v120, v120, v6
  v_exp_f32 v119, v119
  v_sub_f32 v121, v121, v6
  v_exp_f32 v120, v120
  v_sub_f32 v122, v122, v6
  v_exp_f32 v121, v121
  v_sub_f32 v123, v123, v6
  v_exp_f32 v122, v122
  v_sub_f32 v124, v124, v6
  v_exp_f32 v123, v123
  v_sub_f32 v125, v125, v6
  v_exp_f32 v124, v124
  v_sub_f32 v126, v126, v6
  v_exp_f32 v125, v125
  v_sub_f32 v127, v127, v6
  v_exp_f32 v126, v126
  v_exp_f32 v127, v127
  v_cvt_pk_bf16_f32 v112, v112, v113
  v_cvt_pk_bf16_f32 v113, v114, v115
  v_cvt_pk_bf16_f32 v114, v116, v117
  v_cvt_pk_bf16_f32 v115, v118, v119
  v_cvt_pk_bf16_f32 v116, v120, v121
  v_cvt_pk_bf16_f32 v117, v122, v123
  v_cvt_pk_bf16_f32 v118, v124, v125
  v_cvt_pk_bf16_f32 v119, v126, v127
  s_cmp_gt_u32 s14, 3
  s_cbranch_scc1 Lb_pvskip_3
  s_waitcnt lgkmcnt(2)
  v_mfma_f32_32x32x16_bf16 v[192:207], v[208:211], v[112:115], v[192:207]
  v_mfma_f32_32x32x16_bf16 v[192:207], v[212:215], v[116:119], v[192:207]
Lb_pvskip_3:
  ds_read_b128 v[208:211], v4 offset:320
  ds_read_b128 v[212:215], v4 offset:352
  v_sub_f32 v128, v128, v6
  v_sub_f32 v129, v129, v6
  v_exp_f32 v128, v128
  v_sub_f32 v130, v130, v6
  v_exp_f32 v129, v129
  v_sub_f32 v131, v131, v6
  v_exp_f32 v130, v130
  v_sub_f32 v132, v132, v6
  v_exp_f32 v131, v131
  v_sub_f32 v133, v133, v6
  v_exp_f32 v132, v132
  v_sub_f32 v134, v134, v6
  v_exp_f32 v133, v133
  v_sub_f32 v135, v135, v6
  v_exp_f32 v134, v134
  v_sub_f32 v136, v136, v6
  v_exp_f32 v135, v135
  v_sub_f32 v137, v137, v6
  v_exp_f32 v136, v136
  v_sub_f32 v138, v138, v6
  v_exp_f32 v137, v137
  v_sub_f32 v139, v139, v6
  v_exp_f32 v138, v138
  v_sub_f32 v140, v140, v6
  v_exp_f32 v139, v139
  v_sub_f32 v141, v141, v6
  v_exp_f32 v140, v140
  v_sub_f32 v142, v142, v6
  v_exp_f32 v141, v141
  v_sub_f32 v143, v143, v6
  v_exp_f32 v142, v142
  v_exp_f32 v143, v143
  v_cvt_pk_bf16_f32 v128, v128, v129
  v_cvt_pk_bf16_f32 v129, v130, v131
  v_cvt_pk_bf16_f32 v130, v132, v133
  v_cvt_pk_bf16_f32 v131, v134, v135
  v_cvt_pk_bf16_f32 v132, v136, v137
  v_cvt_pk_bf16_f32 v133, v138, v139
  v_cvt_pk_bf16_f32 v134, v140, v141
  v_cvt_pk_bf16_f32 v135, v142, v143
  s_cmp_gt_u32 s14, 4
  s_cbranch_scc1 Lb_pvskip_4
  s_waitcnt lgkmcnt(2)
  v_mfma_f32_32x32x16_bf16 v[192:207], v[216:219], v[128:131], v[192:207]
  v_mfma_f32_32x32x16_bf16 v[192:207], v[220:223], v[132:135], v[192:207]
Lb_pvskip_4:
  ds_read_b128 v[216:219], v4 offset:384
  ds_read_b128 v[220:223], v4 offset:416
  v_sub_f32 v144, v144, v6
  v_sub_f32 v145, v145, v6
  v_exp_f32 v144, v144
  v_sub_f32 v146, v146, v6
  v_exp_f32 v145, v145
  v_sub_f32 v147, v147, v6
  v_exp_f32 v146, v146
  v_sub_f32 v148, v148, v6
  v_exp_f32 v147, v147
  v_sub_f32 v149, v149, v6
  v_exp_f32 v148, v148
  v_sub_f32 v150, v150, v6
  v_exp_f32 v149, v149
  v_sub_f32 v151, v151, v6
  v_exp_f32 v150, v150
  v_sub_f32 v152, v152, v6
  v_exp_f32 v151, v151
  v_sub_f32 v153, v153, v6
  v_exp_f32 v152, v152
  v_sub_f32 v154, v154, v6
  v_exp_f32 v153, v153
  v_sub_f32 v155, v155, v6
  v_exp_f32 v154, v154
  v_sub_f32 v156, v156, v6
  v_exp_f32 v155, v155
  v_sub_f32 v157, v157, v6
  v_exp_f32 v156, v156
  v_sub_f32 v158, v158, v6
  v_exp_f32 v157, v157
  v_sub_f32 v159, v159, v6
  v_exp_f32 v158, v158
  v_exp_f32 v159, v159
  v_cvt_pk_bf16_f32 v144, v144, v145
  v_cvt_pk_bf16_f32 v145, v146, v147
  v_cvt_pk_bf16_f32 v146, v148, v149
  v_cvt_pk_bf16_f32 v147, v150, v151
  v_cvt_pk_bf16_f32 v148, v152, v153
  v_cvt_pk_bf16_f32 v149, v154, v155
  v_cvt_pk_bf16_f32 v150, v156, v157
  v_cvt_pk_bf16_f32 v151, v158, v159
  s_cmp_gt_u32 s14, 5
  s_cbranch_scc1 Lb_pvskip_5
  s_waitcnt lgkmcnt(2)
  v_mfma_f32_32x32x16_bf16 v[192:207], v[208:211], v[144:147], v[192:207]
  v_mfma_f32_32x32x16_bf16 v[192:207], v[212:215], v[148:151], v[192:207]
Lb_pvskip_5:
  ds_read_b128 v[208:211], v4 offset:448
  ds_read_b128 v[212:215], v4 offset:480
  v_sub_f32 v160, v160, v6
  v_sub_f32 v161, v161, v6
  v_exp_f32 v160, v160
  v_sub_f32 v162, v162, v6
  v_exp_f32 v161, v161
  v_sub_f32 v163, v163, v6
  v_exp_f32 v162, v162
  v_sub_f32 v164, v164, v6
  v_exp_f32 v163, v163
  v_sub_f32 v165, v165, v6
  v_exp_f32 v164, v164
  v_sub_f32 v166, v166, v6
  v_exp_f32 v165, v165
  v_sub_f32 v167, v167, v6
  v_exp_f32 v166, v166
  v_sub_f32 v168, v168, v6
  v_exp_f32 v167, v167
  v_sub_f32 v169, v169, v6
  v_exp_f32 v168, v168
  v_sub_f32 v170, v170, v6
  v_exp_f32 v169, v169
  v_sub_f32 v171, v171, v6
  v_exp_f32 v170, v170
  v_sub_f32 v172, v172, v6
  v_exp_f32 v171, v171
  v_sub_f32 v173, v173, v6
  v_exp_f32 v172, v172
  v_sub_f32 v174, v174, v6
  v_exp_f32 v173, v173
  v_sub_f32 v175, v175, v6
  v_exp_f32 v174, v174
  v_exp_f32 v175, v175
  v_cvt_pk_bf16_f32 v160, v160, v161
  v_cvt_pk_bf16_f32 v161, v162, v163
  v_cvt_pk_bf16_f32 v162, v164, v165
  v_cvt_pk_bf16_f32 v163, v166, v167
  v_cvt_pk_bf16_f32 v164, v168, v169
  v_cvt_pk_bf16_f32 v165, v170, v171
  v_cvt_pk_bf16_f32 v166, v172, v173
  v_cvt_pk_bf16_f32 v167, v174, v175
  s_cmp_gt_u32 s14, 6
  s_cbranch_scc1 Lb_pvskip_6
  s_waitcnt lgkmcnt(2)
  v_mfma_f32_32x32x16_bf16 v[192:207], v[216:219], v[160:163], v[192:207]
  v_mfma_f32_32x32x16_bf16 v[192:207], v[220:223], v[164:167], v[192:207]
Lb_pvskip_6:
  ds_read_b128 v[216:219], v4 offset:0
  ds_read_b128 v[220:223], v4 offset:32
  v_sub_f32 v176, v176, v6
  v_sub_f32 v177, v177, v6
  v_exp_f32 v176, v176
  v_sub_f32 v178, v178, v6
  v_exp_f32 v177, v177
  v_sub_f32 v179, v179, v6
  v_exp_f32 v178, v178
  v_sub_f32 v180, v180, v6
  v_exp_f32 v179, v179
  v_sub_f32 v181, v181, v6
  v_exp_f32 v180, v180
  v_sub_f32 v182, v182, v6
  v_exp_f32 v181, v181
  v_sub_f32 v183, v183, v6
  v_exp_f32 v182, v182
  v_sub_f32 v184, v184, v6
  v_exp_f32 v183, v183
  v_sub_f32 v185, v185, v6
  v_exp_f32 v184, v184
  v_sub_f32 v186, v186, v6
  v_exp_f32 v185, v185
  v_sub_f32 v187, v187, v6
  v_exp_f32 v186, v186
  v_sub_f32 v188, v188, v6
  v_exp_f32 v187, v187
  v_sub_f32 v189, v189, v6
  v_exp_f32 v188, v188
  v_sub_f32 v190, v190, v6
  v_exp_f32 v189, v189
  v_sub_f32 v191, v191, v6
  v_exp_f32 v190, v190
  v_exp_f32 v191, v191
  v_cvt_pk_bf16_f32 v176, v176, v177
  v_cvt_pk_bf16_f32 v177, v178, v179
  v_cvt_pk_bf16_f32 v178, v180, v181
  v_cvt_pk_bf16_f32 v179, v182, v183
  v_cvt_pk_bf16_f32 v180, v184, v185
  v_cvt_pk_bf16_f32 v181, v186, v187
  v_cvt_pk_bf16_f32 v182, v188, v189
  v_cvt_pk_bf16_f32 v183, v190, v191
  s_cmp_gt_u32 s14, 7
  s_cbranch_scc1 Lb_pvskip_7
  s_waitcnt lgkmcnt(2)
  v_mfma_f32_32x32x16_bf16 v[192:207], v[208:211], v[176:179], v[192:207]
  v_mfma_f32_32x32x16_bf16 v[192:207], v[212:215], v[180:183], v[192:207]
Lb_pvskip_7:
  s_waitcnt lgkmcnt(0)
  ds_read_b128 v[208:211], v4 offset:512
  ds_read_b128 v[212:215], v4 offset:544
  v_sub_f32 v64, v64, v6
  v_sub_f32 v65, v65, v6
  v_exp_f32 v64, v64
  v_sub_f32 v66, v66, v6
  v_exp_f32 v65, v65
  v_sub_f32 v67, v67, v6
  v_exp_f32 v66, v66
  v_sub_f32 v68, v68, v6
  v_exp_f32 v67, v67
  v_sub_f32 v69, v69, v6
  v_exp_f32 v68, v68
  v_sub_f32 v70, v70, v6
  v_exp_f32 v69, v69
  v_sub_f32 v71, v71, v6
  v_exp_f32 v70, v70
  v_sub_f32 v72, v72, v6
  v_exp_f32 v71, v71
  v_sub_f32 v73, v73, v6
  v_exp_f32 v72, v72
  v_sub_f32 v74, v74, v6
  v_exp_f32 v73, v73
  v_sub_f32 v75, v75, v6
  v_exp_f32 v74, v74
  v_sub_f32 v76, v76, v6
  v_exp_f32 v75, v75
  v_sub_f32 v77, v77, v6
  v_exp_f32 v76, v76
  v_sub_f32 v78, v78, v6
  v_exp_f32 v77, v77
  v_sub_f32 v79, v79, v6
  v_exp_f32 v78, v78
  v_exp_f32 v79, v79
  v_cvt_pk_bf16_f32 v64, v64, v65
  v_cvt_pk_bf16_f32 v65, v66, v67
  v_cvt_pk_bf16_f32 v66, v68, v69
  v_cvt_pk_bf16_f32 v67, v70, v71
  v_cvt_pk_bf16_f32 v68, v72, v73
  v_cvt_pk_bf16_f32 v69, v74, v75
  v_cvt_pk_bf16_f32 v70, v76, v77
  v_cvt_pk_bf16_f32 v71, v78, v79
  s_nop 0
  v_and_b32 v72, v64, v240
  v_bfi_b32 v64, v240, 0, v64
  v_and_b32 v73, v65, v241
  v_bfi_b32 v65, v241, 0, v65
  v_and_b32 v74, v66, v242
  v_bfi_b32 v66, v242, 0, v66
  v_and_b32 v75, v67, v243
  v_bfi_b32 v67, v243, 0, v67
  v_and_b32 v76, v68, v244
  v_bfi_b32 v68, v244, 0, v68
  v_and_b32 v77, v69, v245
  v_bfi_b32 v69, v245, 0, v69
  v_and_b32 v78, v70, v246
  v_bfi_b32 v70, v246, 0, v70
  v_and_b32 v79, v71, v247
  v_bfi_b32 v71, v247, 0, v71
  s_cmp_gt_u32 s14, 0
  s_cbranch_scc1 Lb_pvskip_0
  v_mfma_f32_32x32x16_bf16 v[192:207], v[216:219], v[72:75], v[192:207]
  v_mfma_f32_32x32x16_bf16 v[192:207], v[220:223], v[76:79], v[192:207]
Lb_pvskip_0:
  s_waitcnt lgkmcnt(0)
  v_mfma_f32_32x32x16_bf16 v[192:207], v[208:211], v[64:67], v[192:207]
  v_mfma_f32_32x32x16_bf16 v[192:207], v[212:215], v[68:71], v[192:207]
  s_nop 7
  s_nop 7
  v_mov_b32 v8, v200
  v_mov_b32 v9, v200
  s_nop 1
  v_permlane32_swap_b32 v8, v9
  s_nop 1
  v_rcp_f32 v9, v9
  s_nop 0
  v_mul_f32 v192, v192, v9
  v_mul_f32 v193, v193, v9
  v_mul_f32 v194, v194, v9
  v_mul_f32 v195, v195, v9
  v_mul_f32 v196, v196, v9
  v_mul_f32 v197, v197, v9
  v_mul_f32 v198, v198, v9
  v_mul_f32 v199, v199, v9
  v_mul_f32 v200, v200, v9
  v_mul_f32 v201, v201, v9
  v_mul_f32 v202, v202, v9
  v_mul_f32 v203, v203, v9
  v_cvt_pk_bf16_f32 v10, v192, v193
  v_cvt_pk_bf16_f32 v11, v194, v195
  v_cvt_pk_bf16_f32 v12, v196, v197
  v_cvt_pk_bf16_f32 v13, v198, v199
  v_cvt_pk_bf16_f32 v14, v200, v201
  v_cvt_pk_bf16_f32 v15, v202, v203
  ds_write_b16 v5, v10 offset:0
  ds_write_b16_d16_hi v5, v10 offset:128
  ds_write_b16 v5, v11 offset:256
  ds_write_b16_d16_hi v5, v11 offset:384
  ds_write_b16 v5, v12 offset:1024
  ds_write_b16_d16_hi v5, v12 offset:1152
  ds_write_b16 v5, v13 offset:1280
  ds_write_b16_d16_hi v5, v13 offset:1408
  s_mov_b32 exec_hi, 0
  ds_write_b16 v5, v14 offset:2048
  ds_write_b16_d16_hi v5, v14 offset:2176
  ds_write_b16 v5, v15 offset:2304
  ds_write_b16_d16_hi v5, v15 offset:2432
  s_mov_b32 exec_hi, -1
  s_add_u32 s15, s15, 1
  s_cmp_ge_u32 s15, 2
  s_cbranch_scc1 Lb_att_out
  v_add_u32 v2, 1280, v2
  v_add_u32 v3, 1280, v3
  v_add_u32 v4, 64, v4
  v_add_u32 v5, 64, v5
  v_mov_b32 v224, v232
  v_mov_b32 v225, v233
  v_mov_b32 v226, v234
  v_mov_b32 v227, v235
  v_mov_b32 v228, v236
  v_mov_b32 v229, v237
  v_mov_b32 v230, v238
  v_mov_b32 v231, v239
  s_sub_u32 s24, s14, 1
  s_cmp_eq_u32 s12, 0
  s_cselect_b32 s14, s24, 0
  s_branch Lb_att_tile
Lb_att_out:
  v_lshrrev_b32 v8, 3, v1
  v_and_b32 v9, 7, v1
  v_lshlrev_b32 v9, 4, v9
  v_lshl_add_u32 v10, v8, 7, v9
  s_mul_i32 s24, s22, 2560
  s_add_u32 s24, s24, 143872
  v_add_u32 v10, s24, v10
  v_lshl_add_u32 v11, v8, 12, v9
  s_mul_i32 s24, s13, 20
  s_lshl_b32 s24, s24, 12
  s_lshl_b32 s25, s12, 9
  s_add_u32 s24, s24, s25
  s_lshl_b32 s25, s22, 7
  s_add_u32 s24, s24, s25
  s_add_u32 s24, s24, 13631488
  s_waitcnt lgkmcnt(0)
  ds_read_b128 v[64:67], v10 offset:0
  ds_read_b128 v[68:71], v10 offset:1024
  ds_read_b128 v[72:75], v10 offset:2048
  s_waitcnt lgkmcnt(2)
  buffer_store_dwordx4 v[64:67], v11, s[8:11], s24 offen sc1
  s_add_u32 s24, s24, 32768
  s_waitcnt lgkmcnt(1)
  buffer_store_dwordx4 v[68:71], v11, s[8:11], s24 offen sc1
  s_add_u32 s24, s24, 32768
  s_waitcnt lgkmcnt(0)
  s_mov_b32 exec_hi, 0
  buffer_store_dwordx4 v[72:75], v11, s[8:11], s24 offen sc1
  s_add_u32 s24, s24, 32768
  s_mov_b32 exec_hi, -1
  s_lshl_b32 s28, s13, 3
  s_add_u32 s28, s28, s12
  s_lshl_b32 s28, s28, 7
  s_add_u32 s28, s28, 16351232
  s_mov_b32 s29, 32
  s_mov_b32 s30, 0
  v_mov_b32 v8, 155432
  ds_read_b32 v9, v8
  s_waitcnt lgkmcnt(0)
  v_readfirstlane_b32 s101, v9
  s_nop 3
  s_branch Lb_done
Lb_inv_0:
  v_mov_b32 v64, s32
  v_mov_b32 v65, s32
  v_mov_b32 v66, s32
  v_mov_b32 v67, s32
  v_mov_b32 v68, s32
  v_mov_b32 v69, s32
  v_mov_b32 v70, s32
  v_mov_b32 v71, s32
  v_mov_b32 v72, s32
  v_mov_b32 v73, s32
  v_mov_b32 v74, s32
  v_mov_b32 v75, s32
  v_mov_b32 v76, s32
  v_mov_b32 v77, s32
  v_mov_b32 v78, s32
  v_mov_b32 v79, s32
  s_branch Lb_invb_0
Lb_inv_1:
  v_mov_b32 v80, s32
  v_mov_b32 v81, s32
  v_mov_b32 v82, s32
  v_mov_b32 v83, s32
  v_mov_b32 v84, s32
  v_mov_b32 v85, s32
  v_mov_b32 v86, s32
  v_mov_b32 v87, s32
  v_mov_b32 v88, s32
  v_mov_b32 v89, s32
  v_mov_b32 v90, s32
  v_mov_b32 v91, s32
  v_mov_b32 v92, s32
  v_mov_b32 v93, s32
  v_mov_b32 v94, s32
  v_mov_b32 v95, s32
  s_branch Lb_invb_1
Lb_inv_2:
  v_mov_b32 v96, s32
  v_mov_b32 v97, s32
  v_mov_b32 v98, s32
  v_mov_b32 v99, s32
  v_mov_b32 v100, s32
  v_mov_b32 v101, s32
  v_mov_b32 v102, s32
  v_mov_b32 v103, s32
  v_mov_b32 v104, s32
  v_mov_b32 v105, s32
  v_mov_b32 v106, s32
  v_mov_b32 v107, s32
  v_mov_b32 v108, s32
  v_mov_b32 v109, s32
  v_mov_b32 v110, s32
  v_mov_b32 v111, s32
  s_branch Lb_invb_2
Lb_inv_3:
  v_mov_b32 v112, s32
  v_mov_b32 v113, s32
  v_mov_b32 v114, s32
  v_mov_b32 v115, s32
  v_mov_b32 v116, s32
  v_mov_b32 v117, s32
  v_mov_b32 v118, s32
  v_mov_b32 v119, s32
  v_mov_b32 v120, s32
  v_mov_b32 v121, s32
  v_mov_b32 v122, s32
  v_mov_b32 v123, s32
  v_mov_b32 v124, s32
  v_mov_b32 v125, s32
  v_mov_b32 v126, s32
  v_mov_b32 v127, s32
  s_branch Lb_invb_3
Lb_inv_4:
  v_mov_b32 v128, s32
  v_mov_b32 v129, s32
  v_mov_b32 v130, s32
  v_mov_b32 v131, s32
  v_mov_b32 v132, s32
  v_mov_b32 v133, s32
  v_mov_b32 v134, s32
  v_mov_b32 v135, s32
  v_mov_b32 v136, s32
  v_mov_b32 v137, s32
  v_mov_b32 v138, s32
  v_mov_b32 v139, s32
  v_mov_b32 v140, s32
  v_mov_b32 v141, s32
  v_mov_b32 v142, s32
  v_mov_b32 v143, s32
  s_branch Lb_invb_4
Lb_inv_5:
  v_mov_b32 v144, s32
  v_mov_b32 v145, s32
  v_mov_b32 v146, s32
  v_mov_b32 v147, s32
  v_mov_b32 v148, s32
  v_mov_b32 v149, s32
  v_mov_b32 v150, s32
  v_mov_b32 v151, s32
  v_mov_b32 v152, s32
  v_mov_b32 v153, s32
  v_mov_b32 v154, s32
  v_mov_b32 v155, s32
  v_mov_b32 v156, s32
  v_mov_b32 v157, s32
  v_mov_b32 v158, s32
  v_mov_b32 v159, s32
  s_branch Lb_invb_5
Lb_inv_6:
  v_mov_b32 v160, s32
  v_mov_b32 v161, s32
  v_mov_b32 v162, s32
  v_mov_b32 v163, s32
  v_mov_b32 v164, s32
  v_mov_b32 v165, s32
  v_mov_b32 v166, s32
  v_mov_b32 v167, s32
  v_mov_b32 v168, s32
  v_mov_b32 v169, s32
  v_mov_b32 v170, s32
  v_mov_b32 v171, s32
  v_mov_b32 v172, s32
  v_mov_b32 v173, s32
  v_mov_b32 v174, s32
  v_mov_b32 v175, s32
  s_branch Lb_invb_6
Lb_inv_7:
  v_mov_b32 v176, s32
  v_mov_b32 v177, s32
  v_mov_b32 v178, s32
  v_mov_b32 v179, s32
  v_mov_b32 v180, s32
  v_mov_b32 v181, s32
  v_mov_b32 v182, s32
  v_mov_b32 v183, s32
  v_mov_b32 v184, s32
  v_mov_b32 v185, s32
  v_mov_b32 v186, s32
  v_mov_b32 v187, s32
  v_mov_b32 v188, s32
  v_mov_b32 v189, s32
  v_mov_b32 v190, s32
  v_mov_b32 v191, s32
  s_branch Lb_invb_7
Lb_done:
  s_setprio 0
  s_mov_b32 s16, s20
  s_and_b32 s17, s21, 0xffff
  s_mov_b32 s18, 16388096
  s_mov_b32 s19, 0x20000
  s_add_u32 s29, s29, 155392
  v_mov_b32 v8, s29
  v_mov_b32 v9, 1
  s_waitcnt vmcnt(0)
  s_mov_b64 exec, 1
  ds_add_rtn_u32 v9, v8, v9
  s_mov_b64 exec, -1
  s_waitcnt lgkmcnt(0)
  v_readfirstlane_b32 s29, v9
  s_nop 3
  s_cmp_eq_u32 s29, 3
  s_cbranch_scc0 Lb_nottag
  v_mov_b32 v8, s28
  v_mov_b32 v9, s101
  s_mov_b64 exec, 1
  buffer_store_dword v9, v8, s[16:19], 0 offen sc1
  s_mov_b64 exec, -1
Lb_nottag:
  s_barrier
  s_load_dwordx4 s[36:39], s[0:1], 48
  s_load_dwordx2 s[6:7], s[0:1], 0
  s_load_dwordx2 s[42:43], s[0:1], 64
  s_load_dwordx2 s[20:21], s[0:1], 80
  v_and_b32 v1, 63, v0
  v_lshrrev_b32 v16, 6, v0
  s_lshr_b32 s30, s2, 3
  v_readfirstlane_b32 s22, v16
  s_and_b32 s31, s2, 7
  s_lshr_b32 s32, s31, 1
  s_lshl_b32 s32, s32, 3
  s_and_b32 s33, s30, 7
  s_add_u32 s32, s32, s33
  s_lshl_b32 s29, s32, 6
  s_and_b32 s31, s31, 1
  s_lshl_b32 s31, s31, 2
  s_lshr_b32 s41, s30, 3
  s_add_u32 s41, s41, s31
  s_mul_i32 s28, s41, 80
  s_cmp_ge_u32 s22, 4
  s_cbranch_scc1 Lc_loader
  v_and_b32 v16, 15, v1
  s_lshl_b32 s30, s22, 4
  s_add_u32 s30, s30, s29
  v_add_u32 v16, s30, v16
  v_lshlrev_b32 v17, 1, v16
  v_mul_u32_u24 v16, 1280, v16
  v_lshrrev_b32 v18, 4, v1
  v_lshl_add_u32 v16, v18, 3, v16
  s_lshl_b32 s30, s28, 1
  v_add_u32 v15, s30, v16
  v_bfe_u32 v19, v1, 2, 4
  v_and_b32 v20, 3, v1
  v_lshlrev_b32 v20, 3, v20
  v_mul_u32_u24 v21, 160, v19
  v_add_u32 v11, v21, v20
  v_bfe_u32 v21, v1, 3, 2
  v_xor_b32 v21, s22, v21
  v_lshl_add_u32 v20, v21, 5, v20
  v_lshl_add_u32 v12, v19, 7, v20
  v_mov_b32 v13, v11
  v_mov_b32 v14, v12
  v_mov_b32 v80, 0
  v_mov_b32 v81, 0
  v_mov_b32 v82, 0
  v_mov_b32 v83, 0
  v_mov_b32 v84, 0
  v_mov_b32 v85, 0
  v_mov_b32 v86, 0
  v_mov_b32 v87, 0
  v_mov_b32 v88, 0
  v_mov_b32 v89, 0
  v_mov_b32 v90, 0
  v_mov_b32 v91, 0
  v_mov_b32 v92, 0
  v_mov_b32 v93, 0
  v_mov_b32 v94, 0
  v_mov_b32 v95, 0
  v_mov_b32 v96, 0
  v_mov_b32 v97, 0
  v_mov_b32 v98, 0
  v_mov_b32 v99, 0
  s_mov_b32 s23, 0
  s_mov_b32 s27, 36864
  s_waitcnt lgkmcnt(0)
  s_mov_b32 s16, s42
  s_and_b32 s17, s43, 0xffff
  s_mov_b32 s18, 2621440
  s_mov_b32 s19, 0x20000
  s_mov_b32 s44, s6
  s_and_b32 s45, s7, 0xffff
  s_mov_b32 s46, 2621440
  s_mov_b32 s47, 0x20000
  s_mov_b32 s48, s38
  s_and_b32 s49, s39, 0xffff
  s_mov_b32 s50, 4096
  s_mov_b32 s51, 0x20000
  s_barrier
  s_barrier
  ds_read_b64_tr_b16 v[52:53], v14 offset:5120
  ds_read_b64_tr_b16 v[54:55], v14 offset:7168
  ds_read_b64_tr_b16 v[32:33], v13 offset:0
  ds_read_b64_tr_b16 v[34:35], v13 offset:2560
  ds_read_b64_tr_b16 v[36:37], v13 offset:32
  ds_read_b64_tr_b16 v[38:39], v13 offset:2592
  ds_read_b64_tr_b16 v[40:41], v13 offset:64
  ds_read_b64_tr_b16 v[42:43], v13 offset:2624
  ds_read_b64_tr_b16 v[44:45], v13 offset:96
  ds_read_b64_tr_b16 v[46:47], v13 offset:2656
  ds_read_b64_tr_b16 v[48:49], v13 offset:128
  ds_read_b64_tr_b16 v[50:51], v13 offset:2688
Lc_loop:
  s_waitcnt lgkmcnt(0)
  s_cmp_eq_u32 s23, 13
  s_cbranch_scc0 Lc_nox
  buffer_load_dwordx2 v[100:101], v15, s[44:47], 0 offen offset:0
  buffer_load_dwordx2 v[102:103], v15, s[44:47], 0 offen offset:32
  buffer_load_dwordx2 v[104:105], v15, s[44:47], 0 offen offset:64
  buffer_load_dwordx2 v[106:107], v15, s[44:47], 0 offen offset:96
  buffer_load_dwordx2 v[108:109], v15, s[44:47], 0 offen offset:128
  buffer_load_ushort v110, v17, s[48:51], 0 offen
Lc_nox:
  v_mfma_f32_16x16x32_bf16 v[80:83], v[32:35], v[52:55], v[80:83]
  ds_read_b64_tr_b16 v[76:77], v14 offset:14336
  ds_read_b64_tr_b16 v[78:79], v14 offset:16384
  ds_read_b64_tr_b16 v[56:57], v13 offset:9216
  v_mfma_f32_16x16x32_bf16 v[84:87], v[36:39], v[52:55], v[84:87]
  ds_read_b64_tr_b16 v[58:59], v13 offset:11776
  ds_read_b64_tr_b16 v[60:61], v13 offset:9248
  ds_read_b64_tr_b16 v[62:63], v13 offset:11808
  v_mfma_f32_16x16x32_bf16 v[88:91], v[40:43], v[52:55], v[88:91]
  ds_read_b64_tr_b16 v[64:65], v13 offset:9280
  ds_read_b64_tr_b16 v[66:67], v13 offset:11840
  ds_read_b64_tr_b16 v[68:69], v13 offset:9312
  v_mfma_f32_16x16x32_bf16 v[92:95], v[44:47], v[52:55], v[92:95]
  ds_read_b64_tr_b16 v[70:71], v13 offset:11872
  ds_read_b64_tr_b16 v[72:73], v13 offset:9344
  ds_read_b64_tr_b16 v[74:75], v13 offset:11904
  v_mfma_f32_16x16x32_bf16 v[96:99], v[48:51], v[52:55], v[96:99]
  s_waitcnt lgkmcnt(0)
  v_mfma_f32_16x16x32_bf16 v[80:83], v[56:59], v[76:79], v[80:83]
  ds_read_b64_tr_b16 v[52:53], v14 offset:23552
  ds_read_b64_tr_b16 v[54:55], v14 offset:25600
  ds_read_b64_tr_b16 v[32:33], v13 offset:18432
  v_mfma_f32_16x16x32_bf16 v[84:87], v[60:63], v[76:79], v[84:87]
  ds_read_b64_tr_b16 v[34:35], v13 offset:20992
  ds_read_b64_tr_b16 v[36:37], v13 offset:18464
  ds_read_b64_tr_b16 v[38:39], v13 offset:21024
  v_mfma_f32_16x16x32_bf16 v[88:91], v[64:67], v[76:79], v[88:91]
  ds_read_b64_tr_b16 v[40:41], v13 offset:18496
  ds_read_b64_tr_b16 v[42:43], v13 offset:21056
  ds_read_b64_tr_b16 v[44:45], v13 offset:18528
  v_mfma_f32_16x16x32_bf16 v[92:95], v[68:71], v[76:79], v[92:95]
  ds_read_b64_tr_b16 v[46:47], v13 offset:21088
  ds_read_b64_tr_b16 v[48:49], v13 offset:18560
  ds_read_b64_tr_b16 v[50:51], v13 offset:21120
  v_mfma_f32_16x16x32_bf16 v[96:99], v[72:75], v[76:79], v[96:99]
  s_waitcnt lgkmcnt(0)
  v_mfma_f32_16x16x32_bf16 v[80:83], v[32:35], v[52:55], v[80:83]
  ds_read_b64_tr_b16 v[76:77], v14 offset:32768
  ds_read_b64_tr_b16 v[78:79], v14 offset:34816
  ds_read_b64_tr_b16 v[56:57], v13 offset:27648
  v_mfma_f32_16x16x32_bf16 v[84:87], v[36:39], v[52:55], v[84:87]
  ds_read_b64_tr_b16 v[58:59], v13 offset:30208
  ds_read_b64_tr_b16 v[60:61], v13 offset:27680
  ds_read_b64_tr_b16 v[62:63], v13 offset:30240
  v_mfma_f32_16x16x32_bf16 v[88:91], v[40:43], v[52:55], v[88:91]
  ds_read_b64_tr_b16 v[64:65], v13 offset:27712
  ds_read_b64_tr_b16 v[66:67], v13 offset:30272
  ds_read_b64_tr_b16 v[68:69], v13 offset:27744
  v_mfma_f32_16x16x32_bf16 v[92:95], v[44:47], v[52:55], v[92:95]
  ds_read_b64_tr_b16 v[70:71], v13 offset:30304
  ds_read_b64_tr_b16 v[72:73], v13 offset:27776
  ds_read_b64_tr_b16 v[74:75], v13 offset:30336
  v_mfma_f32_16x16x32_bf16 v[96:99], v[48:51], v[52:55], v[96:99]
  v_add_u32 v13, s27, v11
  v_add_u32 v14, s27, v12
  s_waitcnt lgkmcnt(0)
  s_barrier
  v_mfma_f32_16x16x32_bf16 v[80:83], v[56:59], v[76:79], v[80:83]
  ds_read_b64_tr_b16 v[52:53], v14 offset:5120
  ds_read_b64_tr_b16 v[54:55], v14 offset:7168
  ds_read_b64_tr_b16 v[32:33], v13 offset:0
  v_mfma_f32_16x16x32_bf16 v[84:87], v[60:63], v[76:79], v[84:87]
  ds_read_b64_tr_b16 v[34:35], v13 offset:2560
  ds_read_b64_tr_b16 v[36:37], v13 offset:32
  ds_read_b64_tr_b16 v[38:39], v13 offset:2592
  v_mfma_f32_16x16x32_bf16 v[88:91], v[64:67], v[76:79], v[88:91]
  ds_read_b64_tr_b16 v[40:41], v13 offset:64
  ds_read_b64_tr_b16 v[42:43], v13 offset:2624
  ds_read_b64_tr_b16 v[44:45], v13 offset:96
  v_mfma_f32_16x16x32_bf16 v[92:95], v[68:71], v[76:79], v[92:95]
  ds_read_b64_tr_b16 v[46:47], v13 offset:2656
  ds_read_b64_tr_b16 v[48:49], v13 offset:128
  ds_read_b64_tr_b16 v[50:51], v13 offset:2688
  v_mfma_f32_16x16x32_bf16 v[96:99], v[72:75], v[76:79], v[96:99]
  s_add_u32 s27, s27, 36864
  s_cmp_eq_u32 s27, 147456
  s_cselect_b32 s27, 0, s27
  s_add_u32 s23, s23, 1
  s_cmp_lt_u32 s23, 17
  s_cbranch_scc1 Lc_loop
  s_mul_i32 s30, s22, 2816
  v_and_b32 v18, 15, v1
  v_mul_u32_u24 v20, 176, v18
  v_lshrrev_b32 v18, 4, v1
  v_lshl_add_u32 v20, v18, 3, v20
  v_add_u32 v20, s30, v20
  s_lshl_b32 s31, s22, 4
  s_add_u32 s31, s31, s29
  s_mul_i32 s31, s31, 1280
  s_lshl_b32 s32, s28, 1
  s_add_u32 s31, s31, s32
  s_movk_i32 s32, 6554
  v_add_u32 v18, 0, v1
  v_mul_u32_u24 v19, s32, v18
  v_lshrrev_b32 v19, 16, v19
  v_mul_u32_u24 v27, 10, v19
  v_sub_u32 v18, v18, v27
  v_lshlrev_b32 v18, 4, v18
  v_mul_u32_u24 v27, 176, v19
  v_add3_u32 v21, v27, v18, s30
  v_mul_u32_u24 v27, 1280, v19
  v_add3_u32 v24, v27, v18, s31
  v_add_u32 v18, 64, v1
  v_mul_u32_u24 v19, s32, v18
  v_lshrrev_b32 v19, 16, v19
  v_mul_u32_u24 v27, 10, v19
  v_sub_u32 v18, v18, v27
  v_lshlrev_b32 v18, 4, v18
  v_mul_u32_u24 v27, 176, v19
  v_add3_u32 v22, v27, v18, s30
  v_mul_u32_u24 v27, 1280, v19
  v_add3_u32 v25, v27, v18, s31
  v_add_u32 v18, 128, v1
  v_mul_u32_u24 v19, s32, v18
  v_lshrrev_b32 v19, 16, v19
  v_mul_u32_u24 v27, 10, v19
  v_sub_u32 v18, v18, v27
  v_lshlrev_b32 v18, 4, v18
  v_mul_u32_u24 v27, 176, v19
  v_add3_u32 v23, v27, v18, s30
  v_mul_u32_u24 v27, 1280, v19
  v_add3_u32 v26, v27, v18, s31
  s_waitcnt vmcnt(0)
  v_lshlrev_b32 v110, 16, v110
  v_lshlrev_b32 v18, 16, v100
  v_and_b32 v19, 0xffff0000, v100
  v_add_f32 v18, v18, v110
  v_add_f32 v19, v19, v110
  v_add_f32 v18, v18, v80
  v_add_f32 v19, v19, v81
  v_cvt_pk_bf16_f32 v100, v18, v19
  v_lshlrev_b32 v18, 16, v101
  v_and_b32 v19, 0xffff0000, v101
  v_add_f32 v18, v18, v110
  v_add_f32 v19, v19, v110
  v_add_f32 v18, v18, v82
  v_add_f32 v19, v19, v83
  v_cvt_pk_bf16_f32 v101, v18, v19
  ds_write_b64 v20, v[100:101] offset:0
  v_lshlrev_b32 v18, 16, v102
  v_and_b32 v19, 0xffff0000, v102
  v_add_f32 v18, v18, v110
  v_add_f32 v19, v19, v110
  v_add_f32 v18, v18, v84
  v_add_f32 v19, v19, v85
  v_cvt_pk_bf16_f32 v102, v18, v19
  v_lshlrev_b32 v18, 16, v103
  v_and_b32 v19, 0xffff0000, v103
  v_add_f32 v18, v18, v110
  v_add_f32 v19, v19, v110
  v_add_f32 v18, v18, v86
  v_add_f32 v19, v19, v87
  v_cvt_pk_bf16_f32 v103, v18, v19
  ds_write_b64 v20, v[102:103] offset:32
  v_lshlrev_b32 v18, 16, v104
  v_and_b32 v19, 0xffff0000, v104
  v_add_f32 v18, v18, v110
  v_add_f32 v19, v19, v110
  v_add_f32 v18, v18, v88
  v_add_f32 v19, v19, v89
  v_cvt_pk_bf16_f32 v104, v18, v19
  v_lshlrev_b32 v18, 16, v105
  v_and_b32 v19, 0xffff0000, v105
  v_add_f32 v18, v18, v110
  v_add_f32 v19, v19, v110
  v_add_f32 v18, v18, v90
  v_add_f32 v19, v19, v91
  v_cvt_pk_bf16_f32 v105, v18, v19
  ds_write_b64 v20, v[104:105] offset:64
  v_lshlrev_b32 v18, 16, v106
  v_and_b32 v19, 0xffff0000, v106
  v_add_f32 v18, v18, v110
  v_add_f32 v19, v19, v110
  v_add_f32 v18, v18, v92
  v_add_f32 v19, v19, v93
  v_cvt_pk_bf16_f32 v106, v18, v19
  v_lshlrev_b32 v18, 16, v107
  v_and_b32 v19, 0xffff0000, v107
  v_add_f32 v18, v18, v110
  v_add_f32 v19, v19, v110
  v_add_f32 v18, v18, v94
  v_add_f32 v19, v19, v95
  v_cvt_pk_bf16_f32 v107, v18, v19
  ds_write_b64 v20, v[106:107] offset:96
  v_lshlrev_b32 v18, 16, v108
  v_and_b32 v19, 0xffff0000, v108
  v_add_f32 v18, v18, v110
  v_add_f32 v19, v19, v110
  v_add_f32 v18, v18, v96
  v_add_f32 v19, v19, v97
  v_cvt_pk_bf16_f32 v108, v18, v19
  v_lshlrev_b32 v18, 16, v109
  v_and_b32 v19, 0xffff0000, v109
  v_add_f32 v18, v18, v110
  v_add_f32 v19, v19, v110
  v_add_f32 v18, v18, v98
  v_add_f32 v19, v19, v99
  v_cvt_pk_bf16_f32 v109, v18, v19
  ds_write_b64 v20, v[108:109] offset:128
  s_waitcnt lgkmcnt(0)
  ds_read_b128 v[32:35], v21
  ds_read_b128 v[36:39], v22
  ds_read_b128 v[40:43], v23
  s_waitcnt lgkmcnt(2)
  buffer_store_dwordx4 v[32:35], v24, s[16:19], 0 offen sc1
  s_waitcnt lgkmcnt(1)
  buffer_store_dwordx4 v[36:39], v25, s[16:19], 0 offen sc1
  s_waitcnt lgkmcnt(0)
  s_mov_b32 exec_hi, 0
  buffer_store_dwordx4 v[40:43], v26, s[16:19], 0 offen sc1
  s_mov_b32 exec_hi, -1
  s_endpgm
Lc_loader:
  s_sub_u32 s35, s22, 4
  s_lshl_b32 s30, s35, 5
  s_mul_i32 s40, s30, 160
  s_mul_i32 s31, s41, 348160
  s_add_u32 s40, s40, s31
  v_lshlrev_b32 v2, 4, v1
  v_lshrrev_b32 v16, 3, v1
  v_add_u32 v16, s30, v16
  v_lshlrev_b32 v16, 12, v16
  v_bfe_u32 v17, v1, 4, 2
  v_lshlrev_b32 v17, 1, v17
  v_and_b32 v18, 7, v1
  v_xor_b32 v17, v17, v18
  v_lshl_add_u32 v16, v17, 4, v16
  s_lshl_b32 s31, s29, 1
  v_add_u32 v16, s31, v16
  v_add_u32 v7, 0, v16
  v_add_u32 v8, 31744, v16
  v_add_u32 v9, 63488, v16
  v_add_u32 v10, 95232, v16
  s_mul_i32 s26, s35, 9216
  s_waitcnt lgkmcnt(0)
  v_mov_b32 v112, 155432
  ds_read_b32 v113, v112
  s_waitcnt lgkmcnt(0)
  v_readfirstlane_b32 s101, v113
  s_nop 3
  s_add_u32 s8, s20, 10485760
  s_addc_u32 s9, s21, 0
  s_and_b32 s9, s9, 0xffff
  s_mov_b32 s10, 2785280
  s_mov_b32 s11, 0x20000
  s_mov_b32 s52, s36
  s_and_b32 s53, s37, 0xffff
  s_mov_b32 s54, 6291456
  s_mov_b32 s55, 0x20000
  s_add_u32 s56, s20, 13631488
  s_addc_u32 s57, s21, 0
  s_and_b32 s57, s57, 0xffff
  s_mov_b32 s58, 2621440
  s_mov_b32 s15, 0x20000
  s_mov_b32 s4, 12
  s_mov_b32 s30, 0
  s_cmp_lt_u32 s30, 12
  s_cselect_b32 s12, s52, s56
  s_cselect_b32 s13, s53, s57
  s_cselect_b32 s14, s54, s58
  s_cselect_b32 s25, 0, 12
  s_sub_u32 s25, s30, s25
  s_lshl_b32 s25, s25, 19
  s_add_u32 m0, s26, 5120
  s_nop 0
  buffer_load_dwordx4 v7, s[12:15], s25 offen offset:0 sc1 lds
  buffer_load_dwordx4 v8, s[12:15], s25 offen offset:1024 sc1 lds
  buffer_load_dwordx4 v9, s[12:15], s25 offen offset:2048 sc1 lds
  buffer_load_dwordx4 v10, s[12:15], s25 offen offset:3072 sc1 lds
  s_mov_b32 s30, 1
  s_cmp_lt_u32 s30, 12
  s_cselect_b32 s12, s52, s56
  s_cselect_b32 s13, s53, s57
  s_cselect_b32 s14, s54, s58
  s_cselect_b32 s25, 0, 12
  s_sub_u32 s25, s30, s25
  s_lshl_b32 s25, s25, 19
  s_add_u32 m0, s26, 41984
  s_nop 0
  buffer_load_dwordx4 v7, s[12:15], s25 offen offset:0 sc1 lds
  buffer_load_dwordx4 v8, s[12:15], s25 offen offset:1024 sc1 lds
  buffer_load_dwordx4 v9, s[12:15], s25 offen offset:2048 sc1 lds
  buffer_load_dwordx4 v10, s[12:15], s25 offen offset:3072 sc1 lds
  s_mov_b32 s30, 2
  s_cmp_lt_u32 s30, 12
  s_cselect_b32 s12, s52, s56
  s_cselect_b32 s13, s53, s57
  s_cselect_b32 s14, s54, s58
  s_cselect_b32 s25, 0, 12
  s_sub_u32 s25, s30, s25
  s_lshl_b32 s25, s25, 19
  s_add_u32 m0, s26, 78848
  s_nop 0
  buffer_load_dwordx4 v7, s[12:15], s25 offen offset:0 sc1 lds
  buffer_load_dwordx4 v8, s[12:15], s25 offen offset:1024 sc1 lds
  buffer_load_dwordx4 v9, s[12:15], s25 offen offset:2048 sc1 lds
  buffer_load_dwordx4 v10, s[12:15], s25 offen offset:3072 sc1 lds
  s_cmp_eq_u32 s22, 99
  s_cbranch_scc0 Lc_notouch
  s_lshr_b32 s30, s2, 3
  s_mul_i32 s30, s30, 48
  v_lshrrev_b32 v16, 2, v1
  v_add_u32 v16, s30, v16
  v_lshlrev_b32 v16, 12, v16
  v_and_b32 v17, 3, v1
  v_lshl_add_u32 v16, v17, 7, v16
  s_and_b32 s30, s2, 7
  s_lshl_b32 s30, s30, 9
  buffer_load_dword v120, v16, s[52:55], s30 offen
  s_add_u32 s30, s30, 65536
  buffer_load_dword v121, v16, s[52:55], s30 offen
  s_add_u32 s30, s30, 65536
  buffer_load_dword v122, v16, s[52:55], s30 offen
  s_add_u32 s30, s30, 65536
Lc_notouch:
  s_mov_b32 s60, s20
  s_and_b32 s61, s21, 0xffff
  s_mov_b32 s62, 16388096
  s_mov_b32 s63, 0x20000
  s_mul_i32 s30, s41, 80
  s_lshr_b32 s30, s30, 6
  s_mul_i32 s30, s30, 3072
  s_add_u32 s30, s30, 16318464
  v_lshlrev_b32 v112, 7, v1
  v_add_u32 v112, s30, v112
  s_lshr_b32 s30, s29, 8
  s_lshl_b32 s30, s30, 7
  s_add_u32 s30, s30, 16351232
  v_lshlrev_b32 v113, 10, v1
  v_add_u32 v113, s30, v113
  v_lshlrev_b32 v114, 7, v1
  v_add_u32 v114, 16379904, v114
  v_cmp_gt_u32 vcc, 32, v1
  s_mov_b32 s66, -1
  s_mov_b32 s67, 0xffff
  v_cndmask_b32 v113, v114, v113, vcc
  s_cmp_eq_u32 s22, 4
  s_cbranch_scc0 Lc_nopoll
  s_mov_b32 s31, 0
Lpt_11:
  s_mov_b64 exec, s[66:67]
  buffer_load_dword v114, v112, s[60:63], 0 offen sc1
  s_mov_b64 exec, -1
  s_waitcnt vmcnt(0)
Lpt_11_chk:
  v_cmp_ne_u32 vcc, s101, v114
  s_nop 4
  s_and_b64 vcc, vcc, s[66:67]
  s_cmp_eq_u64 vcc, 0
  s_cbranch_scc1 Lpt_11_ok
  s_add_u32 s31, s31, 1
  s_sleep 2
  s_cmp_lt_u32 s31, 200000
  s_cbranch_scc1 Lpt_11
Lpt_11_ok:
Lc_nopoll:
  s_barrier
  s_mov_b32 s30, 0
  s_add_u32 m0, s26, 0
  s_mul_i32 s24, s30, 20480
  s_add_u32 s24, s24, s40
  buffer_load_dwordx4 v2, s[8:11], s24 offen offset:0 sc1 lds
  buffer_load_dwordx4 v2, s[8:11], s24 offen offset:1024 sc1 lds
  buffer_load_dwordx4 v2, s[8:11], s24 offen offset:2048 sc1 lds
  buffer_load_dwordx4 v2, s[8:11], s24 offen offset:3072 sc1 lds
  s_add_u32 m0, s26, 4096
  s_add_u32 s24, s24, 4096
  buffer_load_dwordx4 v2, s[8:11], s24 offen sc1 lds
  s_mov_b32 s30, 1
  s_add_u32 m0, s26, 36864
  s_mul_i32 s24, s30, 20480
  s_add_u32 s24, s24, s40
  buffer_load_dwordx4 v2, s[8:11], s24 offen offset:0 sc1 lds
  buffer_load_dwordx4 v2, s[8:11], s24 offen offset:1024 sc1 lds
  buffer_load_dwordx4 v2, s[8:11], s24 offen offset:2048 sc1 lds
  buffer_load_dwordx4 v2, s[8:11], s24 offen offset:3072 sc1 lds
  s_add_u32 m0, s26, 40960
  s_add_u32 s24, s24, 4096
  buffer_load_dwordx4 v2, s[8:11], s24 offen sc1 lds
  s_mov_b32 s30, 2
  s_add_u32 m0, s26, 73728
  s_mul_i32 s24, s30, 20480
  s_add_u32 s24, s24, s40
  buffer_load_dwordx4 v2, s[8:11], s24 offen offset:0 sc1 lds
  buffer_load_dwordx4 v2, s[8:11], s24 offen offset:1024 sc1 lds
  buffer_load_dwordx4 v2, s[8:11], s24 offen offset:2048 sc1 lds
  buffer_load_dwordx4 v2, s[8:11], s24 offen offset:3072 sc1 lds
  s_add_u32 m0, s26, 77824
  s_add_u32 s24, s24, 4096
  buffer_load_dwordx4 v2, s[8:11], s24 offen sc1 lds
  s_mov_b32 s4, 3
  s_waitcnt vmcnt(10)
  s_barrier
  s_mov_b32 s4, 3
  s_add_u32 m0, s26, 110592
  s_mul_i32 s24, s4, 20480
  s_add_u32 s24, s24, s40
  buffer_load_dwordx4 v2, s[8:11], s24 offen offset:0 sc1 lds
  buffer_load_dwordx4 v2, s[8:11], s24 offen offset:1024 sc1 lds
  buffer_load_dwordx4 v2, s[8:11], s24 offen offset:2048 sc1 lds
  buffer_load_dwordx4 v2, s[8:11], s24 offen offset:3072 sc1 lds
  s_add_u32 m0, s26, 114688
  s_add_u32 s24, s24, 4096
  buffer_load_dwordx4 v2, s[8:11], s24 offen sc1 lds
  s_cmp_lt_u32 s4, 12
  s_cselect_b32 s12, s52, s56
  s_cselect_b32 s13, s53, s57
  s_cselect_b32 s14, s54, s58
  s_cselect_b32 s25, 0, 12
  s_sub_u32 s25, s4, s25
  s_lshl_b32 s25, s25, 19
  s_add_u32 m0, s26, 115712
  s_nop 0
  buffer_load_dwordx4 v7, s[12:15], s25 offen offset:0 sc1 lds
  buffer_load_dwordx4 v8, s[12:15], s25 offen offset:1024 sc1 lds
  buffer_load_dwordx4 v9, s[12:15], s25 offen offset:2048 sc1 lds
  buffer_load_dwordx4 v10, s[12:15], s25 offen offset:3072 sc1 lds
  s_add_u32 s4, s4, 1
  s_cmp_eq_u32 s4, 17
  s_cselect_b32 s4, 0, s4
  s_waitcnt vmcnt(14)
  s_barrier
  s_mov_b32 s4, 4
  s_add_u32 m0, s26, 0
  s_mul_i32 s24, s4, 20480
  s_add_u32 s24, s24, s40
  buffer_load_dwordx4 v2, s[8:11], s24 offen offset:0 sc1 lds
  buffer_load_dwordx4 v2, s[8:11], s24 offen offset:1024 sc1 lds
  buffer_load_dwordx4 v2, s[8:11], s24 offen offset:2048 sc1 lds
  buffer_load_dwordx4 v2, s[8:11], s24 offen offset:3072 sc1 lds
  s_add_u32 m0, s26, 4096
  s_add_u32 s24, s24, 4096
  buffer_load_dwordx4 v2, s[8:11], s24 offen sc1 lds
  s_cmp_lt_u32 s4, 12
  s_cselect_b32 s12, s52, s56
  s_cselect_b32 s13, s53, s57
  s_cselect_b32 s14, s54, s58
  s_cselect_b32 s25, 0, 12
  s_sub_u32 s25, s4, s25
  s_lshl_b32 s25, s25, 19
  s_add_u32 m0, s26, 5120
  s_nop 0
  buffer_load_dwordx4 v7, s[12:15], s25 offen offset:0 sc1 lds
  buffer_load_dwordx4 v8, s[12:15], s25 offen offset:1024 sc1 lds
  buffer_load_dwordx4 v9, s[12:15], s25 offen offset:2048 sc1 lds
  buffer_load_dwordx4 v10, s[12:15], s25 offen offset:3072 sc1 lds
  s_add_u32 s4, s4, 1
  s_cmp_eq_u32 s4, 17
  s_cselect_b32 s4, 0, s4
  s_waitcnt vmcnt(18)
  s_barrier
  s_mov_b32 s4, 5
  s_add_u32 m0, s26, 36864
  s_mul_i32 s24, s4, 20480
  s_add_u32 s24, s24, s40
  buffer_load_dwordx4 v2, s[8:11], s24 offen offset:0 sc1 lds
  buffer_load_dwordx4 v2, s[8:11], s24 offen offset:1024 sc1 lds
  buffer_load_dwordx4 v2, s[8:11], s24 offen offset:2048 sc1 lds
  buffer_load_dwordx4 v2, s[8:11], s24 offen offset:3072 sc1 lds
  s_add_u32 m0, s26, 40960
  s_add_u32 s24, s24, 4096
  buffer_load_dwordx4 v2, s[8:11], s24 offen sc1 lds
  s_cmp_lt_u32 s4, 12
  s_cselect_b32 s12, s52, s56
  s_cselect_b32 s13, s53, s57
  s_cselect_b32 s14, s54, s58
  s_cselect_b32 s25, 0, 12
  s_sub_u32 s25, s4, s25
  s_lshl_b32 s25, s25, 19
  s_add_u32 m0, s26, 41984
  s_nop 0
  buffer_load_dwordx4 v7, s[12:15], s25 offen offset:0 sc1 lds
  buffer_load_dwordx4 v8, s[12:15], s25 offen offset:1024 sc1 lds
  buffer_load_dwordx4 v9, s[12:15], s25 offen offset:2048 sc1 lds
  buffer_load_dwordx4 v10, s[12:15], s25 offen offset:3072 sc1 lds
  s_add_u32 s4, s4, 1
  s_cmp_eq_u32 s4, 17
  s_cselect_b32 s4, 0, s4
  s_waitcnt vmcnt(18)
  s_barrier
  s_mov_b32 s4, 6
  s_add_u32 m0, s26, 73728
  s_mul_i32 s24, s4, 20480
  s_add_u32 s24, s24, s40
  buffer_load_dwordx4 v2, s[8:11], s24 offen offset:0 sc1 lds
  buffer_load_dwordx4 v2, s[8:11], s24 offen offset:1024 sc1 lds
  buffer_load_dwordx4 v2, s[8:11], s24 offen offset:2048 sc1 lds
  buffer_load_dwordx4 v2, s[8:11], s24 offen offset:3072 sc1 lds
  s_add_u32 m0, s26, 77824
  s_add_u32 s24, s24, 4096
  buffer_load_dwordx4 v2, s[8:11], s24 offen sc1 lds
  s_cmp_lt_u32 s4, 12
  s_cselect_b32 s12, s52, s56
  s_cselect_b32 s13, s53, s57
  s_cselect_b32 s14, s54, s58
  s_cselect_b32 s25, 0, 12
  s_sub_u32 s25, s4, s25
  s_lshl_b32 s25, s25, 19
  s_add_u32 m0, s26, 78848
  s_nop 0
  buffer_load_dwordx4 v7, s[12:15], s25 offen offset:0 sc1 lds
  buffer_load_dwordx4 v8, s[12:15], s25 offen offset:1024 sc1 lds
  buffer_load_dwordx4 v9, s[12:15], s25 offen offset:2048 sc1 lds
  buffer_load_dwordx4 v10, s[12:15], s25 offen offset:3072 sc1 lds
  s_add_u32 s4, s4, 1
  s_cmp_eq_u32 s4, 17
  s_cselect_b32 s4, 0, s4
  s_waitcnt vmcnt(18)
  s_barrier
  s_mov_b32 s4, 7
  s_add_u32 m0, s26, 110592
  s_mul_i32 s24, s4, 20480
  s_add_u32 s24, s24, s40
  buffer_load_dwordx4 v2, s[8:11], s24 offen offset:0 sc1 lds
  buffer_load_dwordx4 v2, s[8:11], s24 offen offset:1024 sc1 lds
  buffer_load_dwordx4 v2, s[8:11], s24 offen offset:2048 sc1 lds
  buffer_load_dwordx4 v2, s[8:11], s24 offen offset:3072 sc1 lds
  s_add_u32 m0, s26, 114688
  s_add_u32 s24, s24, 4096
  buffer_load_dwordx4 v2, s[8:11], s24 offen sc1 lds
  s_cmp_lt_u32 s4, 12
  s_cselect_b32 s12, s52, s56
  s_cselect_b32 s13, s53, s57
  s_cselect_b32 s14, s54, s58
  s_cselect_b32 s25, 0, 12
  s_sub_u32 s25, s4, s25
  s_lshl_b32 s25, s25, 19
  s_add_u32 m0, s26, 115712
  s_nop 0
  buffer_load_dwordx4 v7, s[12:15], s25 offen offset:0 sc1 lds
  buffer_load_dwordx4 v8, s[12:15], s25 offen offset:1024 sc1 lds
  buffer_load_dwordx4 v9, s[12:15], s25 offen offset:2048 sc1 lds
  buffer_load_dwordx4 v10, s[12:15], s25 offen offset:3072 sc1 lds
  s_add_u32 s4, s4, 1
  s_cmp_eq_u32 s4, 17
  s_cselect_b32 s4, 0, s4
  s_waitcnt vmcnt(18)
  s_barrier
  s_mov_b32 s4, 8
  s_add_u32 m0, s26, 0
  s_mul_i32 s24, s4, 20480
  s_add_u32 s24, s24, s40
  buffer_load_dwordx4 v2, s[8:11], s24 offen offset:0 sc1 lds
  buffer_load_dwordx4 v2, s[8:11], s24 offen offset:1024 sc1 lds
  buffer_load_dwordx4 v2, s[8:11], s24 offen offset:2048 sc1 lds
  buffer_load_dwordx4 v2, s[8:11], s24 offen offset:3072 sc1 lds
  s_add_u32 m0, s26, 4096
  s_add_u32 s24, s24, 4096
  buffer_load_dwordx4 v2, s[8:11], s24 offen sc1 lds
  s_cmp_lt_u32 s4, 12
  s_cselect_b32 s12, s52, s56
  s_cselect_b32 s13, s53, s57
  s_cselect_b32 s14, s54, s58
  s_cselect_b32 s25, 0, 12
  s_sub_u32 s25, s4, s25
  s_lshl_b32 s25, s25, 19
  s_add_u32 m0, s26, 5120
  s_nop 0
  buffer_load_dwordx4 v7, s[12:15], s25 offen offset:0 sc1 lds
  buffer_load_dwordx4 v8, s[12:15], s25 offen offset:1024 sc1 lds
  buffer_load_dwordx4 v9, s[12:15], s25 offen offset:2048 sc1 lds
  buffer_load_dwordx4 v10, s[12:15], s25 offen offset:3072 sc1 lds
  s_add_u32 s4, s4, 1
  s_cmp_eq_u32 s4, 17
  s_cselect_b32 s4, 0, s4
  s_waitcnt vmcnt(18)
  s_barrier
  s_mov_b32 s4, 9
  s_add_u32 m0, s26, 36864
  s_mul_i32 s24, s4, 20480
  s_add_u32 s24, s24, s40
  buffer_load_dwordx4 v2, s[8:11], s24 offen offset:0 sc1 lds
  buffer_load_dwordx4 v2, s[8:11], s24 offen offset:1024 sc1 lds
  buffer_load_dwordx4 v2, s[8:11], s24 offen offset:2048 sc1 lds
  buffer_load_dwordx4 v2, s[8:11], s24 offen offset:3072 sc1 lds
  s_add_u32 m0, s26, 40960
  s_add_u32 s24, s24, 4096
  buffer_load_dwordx4 v2, s[8:11], s24 offen sc1 lds
  s_cmp_lt_u32 s4, 12
  s_cselect_b32 s12, s52, s56
  s_cselect_b32 s13, s53, s57
  s_cselect_b32 s14, s54, s58
  s_cselect_b32 s25, 0, 12
  s_sub_u32 s25, s4, s25
  s_lshl_b32 s25, s25, 19
  s_add_u32 m0, s26, 41984
  s_nop 0
  buffer_load_dwordx4 v7, s[12:15], s25 offen offset:0 sc1 lds
  buffer_load_dwordx4 v8, s[12:15], s25 offen offset:1024 sc1 lds
  buffer_load_dwordx4 v9, s[12:15], s25 offen offset:2048 sc1 lds
  buffer_load_dwordx4 v10, s[12:15], s25 offen offset:3072 sc1 lds
  s_add_u32 s4, s4, 1
  s_cmp_eq_u32 s4, 17
  s_cselect_b32 s4, 0, s4
  s_waitcnt vmcnt(18)
  s_barrier
  s_mov_b32 s4, 10
  s_add_u32 m0, s26, 73728
  s_mul_i32 s24, s4, 20480
  s_add_u32 s24, s24, s40
  buffer_load_dwordx4 v2, s[8:11], s24 offen offset:0 sc1 lds
  buffer_load_dwordx4 v2, s[8:11], s24 offen offset:1024 sc1 lds
  buffer_load_dwordx4 v2, s[8:11], s24 offen offset:2048 sc1 lds
  buffer_load_dwordx4 v2, s[8:11], s24 offen offset:3072 sc1 lds
  s_add_u32 m0, s26, 77824
  s_add_u32 s24, s24, 4096
  buffer_load_dwordx4 v2, s[8:11], s24 offen sc1 lds
  s_cmp_lt_u32 s4, 12
  s_cselect_b32 s12, s52, s56
  s_cselect_b32 s13, s53, s57
  s_cselect_b32 s14, s54, s58
  s_cselect_b32 s25, 0, 12
  s_sub_u32 s25, s4, s25
  s_lshl_b32 s25, s25, 19
  s_add_u32 m0, s26, 78848
  s_nop 0
  buffer_load_dwordx4 v7, s[12:15], s25 offen offset:0 sc1 lds
  buffer_load_dwordx4 v8, s[12:15], s25 offen offset:1024 sc1 lds
  buffer_load_dwordx4 v9, s[12:15], s25 offen offset:2048 sc1 lds
  buffer_load_dwordx4 v10, s[12:15], s25 offen offset:3072 sc1 lds
  s_add_u32 s4, s4, 1
  s_cmp_eq_u32 s4, 17
  s_cselect_b32 s4, 0, s4
  s_waitcnt vmcnt(18)
  s_barrier
  s_mov_b64 exec, s[66:67]
  buffer_load_dword v115, v113, s[60:63], 0 offen sc1
  s_mov_b64 exec, -1
  s_mov_b32 s4, 11
  s_add_u32 m0, s26, 110592
  s_mul_i32 s24, s4, 20480
  s_add_u32 s24, s24, s40
  buffer_load_dwordx4 v2, s[8:11], s24 offen offset:0 sc1 lds
  buffer_load_dwordx4 v2, s[8:11], s24 offen offset:1024 sc1 lds
  buffer_load_dwordx4 v2, s[8:11], s24 offen offset:2048 sc1 lds
  buffer_load_dwordx4 v2, s[8:11], s24 offen offset:3072 sc1 lds
  s_add_u32 m0, s26, 114688
  s_add_u32 s24, s24, 4096
  buffer_load_dwordx4 v2, s[8:11], s24 offen sc1 lds
  s_cmp_lt_u32 s4, 12
  s_cselect_b32 s12, s52, s56
  s_cselect_b32 s13, s53, s57
  s_cselect_b32 s14, s54, s58
  s_cselect_b32 s25, 0, 12
  s_sub_u32 s25, s4, s25
  s_lshl_b32 s25, s25, 19
  s_add_u32 m0, s26, 115712
  s_nop 0
  buffer_load_dwordx4 v7, s[12:15], s25 offen offset:0 sc1 lds
  buffer_load_dwordx4 v8, s[12:15], s25 offen offset:1024 sc1 lds
  buffer_load_dwordx4 v9, s[12:15], s25 offen offset:2048 sc1 lds
  buffer_load_dwordx4 v10, s[12:15], s25 offen offset:3072 sc1 lds
  s_add_u32 s4, s4, 1
  s_cmp_eq_u32 s4, 17
  s_cselect_b32 s4, 0, s4
  s_waitcnt vmcnt(19)
  s_barrier
  s_waitcnt vmcnt(9)
  s_mov_b32 s31, 0
  v_mov_b32 v114, v115
  s_branch Lpt_12_chk
Lpt_12:
  s_mov_b64 exec, s[66:67]
  buffer_load_dword v114, v113, s[60:63], 0 offen sc1
  s_mov_b64 exec, -1
  s_waitcnt vmcnt(0)
Lpt_12_chk:
  v_cmp_ne_u32 vcc, s101, v114
  s_nop 4
  s_and_b64 vcc, vcc, s[66:67]
  s_cmp_eq_u64 vcc, 0
  s_cbranch_scc1 Lpt_12_ok
  s_add_u32 s31, s31, 1
  s_sleep 4
  s_cmp_lt_u32 s31, 200000
  s_cbranch_scc1 Lpt_12
Lpt_12_ok:
  s_mov_b32 s4, 12
  s_add_u32 m0, s26, 0
  s_mul_i32 s24, s4, 20480
  s_add_u32 s24, s24, s40
  buffer_load_dwordx4 v2, s[8:11], s24 offen offset:0 sc1 lds
  buffer_load_dwordx4 v2, s[8:11], s24 offen offset:1024 sc1 lds
  buffer_load_dwordx4 v2, s[8:11], s24 offen offset:2048 sc1 lds
  buffer_load_dwordx4 v2, s[8:11], s24 offen offset:3072 sc1 lds
  s_add_u32 m0, s26, 4096
  s_add_u32 s24, s24, 4096
  buffer_load_dwordx4 v2, s[8:11], s24 offen sc1 lds
  s_cmp_lt_u32 s4, 12
  s_cselect_b32 s12, s52, s56
  s_cselect_b32 s13, s53, s57
  s_cselect_b32 s14, s54, s58
  s_cselect_b32 s25, 0, 12
  s_sub_u32 s25, s4, s25
  s_lshl_b32 s25, s25, 19
  s_add_u32 m0, s26, 5120
  s_nop 0
  buffer_load_dwordx4 v7, s[12:15], s25 offen offset:0 sc1 lds
  buffer_load_dwordx4 v8, s[12:15], s25 offen offset:1024 sc1 lds
  buffer_load_dwordx4 v9, s[12:15], s25 offen offset:2048 sc1 lds
  buffer_load_dwordx4 v10, s[12:15], s25 offen offset:3072 sc1 lds
  s_add_u32 s4, s4, 1
  s_cmp_eq_u32 s4, 17
  s_cselect_b32 s4, 0, s4
  s_waitcnt vmcnt(19)
  s_barrier
  s_mov_b32 s4, 13
  s_add_u32 m0, s26, 36864
  s_mul_i32 s24, s4, 20480
  s_add_u32 s24, s24, s40
  buffer_load_dwordx4 v2, s[8:11], s24 offen offset:0 sc1 lds
  buffer_load_dwordx4 v2, s[8:11], s24 offen offset:1024 sc1 lds
  buffer_load_dwordx4 v2, s[8:11], s24 offen offset:2048 sc1 lds
  buffer_load_dwordx4 v2, s[8:11], s24 offen offset:3072 sc1 lds
  s_add_u32 m0, s26, 40960
  s_add_u32 s24, s24, 4096
  buffer_load_dwordx4 v2, s[8:11], s24 offen sc1 lds
  s_cmp_lt_u32 s4, 12
  s_cselect_b32 s12, s52, s56
  s_cselect_b32 s13, s53, s57
  s_cselect_b32 s14, s54, s58
  s_cselect_b32 s25, 0, 12
  s_sub_u32 s25, s4, s25
  s_lshl_b32 s25, s25, 19
  s_add_u32 m0, s26, 41984
  s_nop 0
  buffer_load_dwordx4 v7, s[12:15], s25 offen offset:0 sc1 lds
  buffer_load_dwordx4 v8, s[12:15], s25 offen offset:1024 sc1 lds
  buffer_load_dwordx4 v9, s[12:15], s25 offen offset:2048 sc1 lds
  buffer_load_dwordx4 v10, s[12:15], s25 offen offset:3072 sc1 lds
  s_add_u32 s4, s4, 1
  s_cmp_eq_u32 s4, 17
  s_cselect_b32 s4, 0, s4
  s_waitcnt vmcnt(18)
  s_barrier
  s_mov_b32 s4, 14
  s_add_u32 m0, s26, 73728
  s_mul_i32 s24, s4, 20480
  s_add_u32 s24, s24, s40
  buffer_load_dwordx4 v2, s[8:11], s24 offen offset:0 sc1 lds
  buffer_load_dwordx4 v2, s[8:11], s24 offen offset:1024 sc1 lds
  buffer_load_dwordx4 v2, s[8:11], s24 offen offset:2048 sc1 lds
  buffer_load_dwordx4 v2, s[8:11], s24 offen offset:3072 sc1 lds
  s_add_u32 m0, s26, 77824
  s_add_u32 s24, s24, 4096
  buffer_load_dwordx4 v2, s[8:11], s24 offen sc1 lds
  s_cmp_lt_u32 s4, 12
  s_cselect_b32 s12, s52, s56
  s_cselect_b32 s13, s53, s57
  s_cselect_b32 s14, s54, s58
  s_cselect_b32 s25, 0, 12
  s_sub_u32 s25, s4, s25
  s_lshl_b32 s25, s25, 19
  s_add_u32 m0, s26, 78848
  s_nop 0
  buffer_load_dwordx4 v7, s[12:15], s25 offen offset:0 sc1 lds
  buffer_load_dwordx4 v8, s[12:15], s25 offen offset:1024 sc1 lds
  buffer_load_dwordx4 v9, s[12:15], s25 offen offset:2048 sc1 lds
  buffer_load_dwordx4 v10, s[12:15], s25 offen offset:3072 sc1 lds
  s_add_u32 s4, s4, 1
  s_cmp_eq_u32 s4, 17
  s_cselect_b32 s4, 0, s4
  s_waitcnt vmcnt(18)
  s_barrier
  s_mov_b32 s4, 15
  s_add_u32 m0, s26, 110592
  s_mul_i32 s24, s4, 20480
  s_add_u32 s24, s24, s40
  buffer_load_dwordx4 v2, s[8:11], s24 offen offset:0 sc1 lds
  buffer_load_dwordx4 v2, s[8:11], s24 offen offset:1024 sc1 lds
  buffer_load_dwordx4 v2, s[8:11], s24 offen offset:2048 sc1 lds
  buffer_load_dwordx4 v2, s[8:11], s24 offen offset:3072 sc1 lds
  s_add_u32 m0, s26, 114688
  s_add_u32 s24, s24, 4096
  buffer_load_dwordx4 v2, s[8:11], s24 offen sc1 lds
  s_cmp_lt_u32 s4, 12
  s_cselect_b32 s12, s52, s56
  s_cselect_b32 s13, s53, s57
  s_cselect_b32 s14, s54, s58
  s_cselect_b32 s25, 0, 12
  s_sub_u32 s25, s4, s25
  s_lshl_b32 s25, s25, 19
  s_add_u32 m0, s26, 115712
  s_nop 0
  buffer_load_dwordx4 v7, s[12:15], s25 offen offset:0 sc1 lds
  buffer_load_dwordx4 v8, s[12:15], s25 offen offset:1024 sc1 lds
  buffer_load_dwordx4 v9, s[12:15], s25 offen offset:2048 sc1 lds
  buffer_load_dwordx4 v10, s[12:15], s25 offen offset:3072 sc1 lds
  s_add_u32 s4, s4, 1
  s_cmp_eq_u32 s4, 17
  s_cselect_b32 s4, 0, s4
  s_waitcnt vmcnt(18)
  s_barrier
  s_mov_b32 s4, 16
  s_add_u32 m0, s26, 0
  s_mul_i32 s24, s4, 20480
  s_add_u32 s24, s24, s40
  buffer_load_dwordx4 v2, s[8:11], s24 offen offset:0 sc1 lds
  buffer_load_dwordx4 v2, s[8:11], s24 offen offset:1024 sc1 lds
  buffer_load_dwordx4 v2, s[8:11], s24 offen offset:2048 sc1 lds
  buffer_load_dwordx4 v2, s[8:11], s24 offen offset:3072 sc1 lds
  s_add_u32 m0, s26, 4096
  s_add_u32 s24, s24, 4096
  buffer_load_dwordx4 v2, s[8:11], s24 offen sc1 lds
  s_cmp_lt_u32 s4, 12
  s_cselect_b32 s12, s52, s56
  s_cselect_b32 s13, s53, s57
  s_cselect_b32 s14, s54, s58
  s_cselect_b32 s25, 0, 12
  s_sub_u32 s25, s4, s25
  s_lshl_b32 s25, s25, 19
  s_add_u32 m0, s26, 5120
  s_nop 0
  buffer_load_dwordx4 v7, s[12:15], s25 offen offset:0 sc1 lds
  buffer_load_dwordx4 v8, s[12:15], s25 offen offset:1024 sc1 lds
  buffer_load_dwordx4 v9, s[12:15], s25 offen offset:2048 sc1 lds
  buffer_load_dwordx4 v10, s[12:15], s25 offen offset:3072 sc1 lds
  s_add_u32 s4, s4, 1
  s_cmp_eq_u32 s4, 17
  s_cselect_b32 s4, 0, s4
  s_waitcnt vmcnt(18)
  s_barrier
  s_waitcnt vmcnt(9)
  s_barrier
  s_waitcnt vmcnt(0)
  s_barrier
  s_barrier
  s_endpgm
Lm_exit:
  s_endpgm
.section .rodata,"a"
.p2align 6
.amdhsa_kernel parallel_sum__sliding_block__mixer_token_mlp__prompt_kernel
  .amdhsa_next_free_vgpr 248
  .amdhsa_next_free_sgpr 102
  .amdhsa_accum_offset 248
  .amdhsa_group_segment_fixed_size 0
  .amdhsa_kernarg_size 88
  .amdhsa_user_sgpr_count 2
  .amdhsa_user_sgpr_kernarg_segment_ptr 1
  .amdhsa_system_sgpr_workgroup_id_x 1
  .amdhsa_float_denorm_mode_32 3
.end_amdhsa_kernel
```
